```python
import torch

def _softmax(x, axis=-1):
    return torch.softmax(x, dim=axis)
def _gelu(x):
    return torch.nn.functional.gelu(x, approximate="tanh")
def _silu(x):
    return torch.nn.functional.silu(x)
def _sigmoid(x):
    return torch.sigmoid(x)
def _layernorm(x, axis=-1, eps=1e-5):
    m = x.mean(dim=axis, keepdim=True)
    v = x.var(dim=axis, keepdim=True, unbiased=False)
    return (x - m) / torch.sqrt(v + eps)
def _scatter_add(tgt, idx, src, axis=0):
    return tgt.clone().index_add_(axis, idx, src)
def _segment_sum(src, seg, n):
    out = torch.zeros((n,) + src.shape[1:], dtype=src.dtype)
    return out.index_add_(0, seg, src)
def _pad(x, pw):
    flat = tuple(v for pair in reversed(pw) for v in pair)
    return torch.nn.functional.pad(x, flat)

kernel_name = 'recurrent_scan__gqa_block_cached__glu_gated_geglu__decode'

def setup_inputs():

    _w = (lambda a: (lambda t: t.to(torch.bfloat16) if t.is_floating_point() else t)(torch.as_tensor(a)))
    def _A_setup():
        B, Sq, D = 2, 1, 448
        Hq, Hkv, Sk, Dh = 16, 8, 32768, 256
        assert Hq % Hkv == 0, (Hq, Hkv)
        return {
            "x": _w((lambda *s: torch.randn(*s, dtype=torch.bfloat16) * 0.4)(B, Sq, D)),
            "k_cache": _w((lambda *s: torch.randn(*s, dtype=torch.bfloat16) * 1.6)(B, Hkv, Sk, Dh)),
            "v_cache": _w((lambda *s: torch.randn(*s, dtype=torch.bfloat16) * 1.6)(B, Hkv, Sk, Dh)),
            "wq": _w((lambda *s: torch.randn(*s, dtype=torch.bfloat16) * 1.6)(D, Hq * Dh) * (D ** -0.5)),
            "wo": _w((lambda *s: torch.randn(*s, dtype=torch.bfloat16) * 1.6)(Hq * Dh, D) * ((Hq * Dh) ** -0.5)),
        }
    _A_in = _A_setup()

    def _B_setup():
        B, S, Dm, Df = 2, 1, 448, 1792
        return {
            "x": _w((lambda *s: torch.randn(*s, dtype=torch.bfloat16) * 0.4)(B, S, Dm)),
            "w_gate": _w((lambda *s: torch.randn(*s, dtype=torch.bfloat16) * 1.6)(Dm, Df) * (Dm ** -0.5)),
            "w_up": _w((lambda *s: torch.randn(*s, dtype=torch.bfloat16) * 1.6)(Dm, Df) * (Dm ** -0.5)),
            "w_down": _w((lambda *s: torch.randn(*s, dtype=torch.bfloat16) * 1.6)(Df, Dm) * (Df ** -0.5)),
        }
    _B_in = _B_setup()

    return {
        "A_x": _A_in["x"],
        "A_k_cache": _A_in["k_cache"],
        "A_v_cache": _A_in["v_cache"],
        "A_wq": _A_in["wq"],
        "A_wo": _A_in["wo"],
        "B_x": _B_in["x"],
        "B_w_gate": _B_in["w_gate"],
        "B_w_up": _B_in["w_up"],
        "B_w_down": _B_in["w_down"],
    }

def reference(A_x, A_k_cache, A_v_cache, A_wq, A_wo, B_x, B_w_gate, B_w_up, B_w_down):
    def _A_ref(x, k_cache, v_cache, wq, wo):
        B, Sq, D = x.shape
        Hq, Dh = 16, 256
        Hkv = k_cache.shape[1]
        rep = Hq // Hkv
        q = (lambda x, *d: x.permute(*d))((x @ wq).reshape(B, Sq, Hq, Dh), 0, 2, 1, 3)
        k = (lambda x, n, axis: torch.repeat_interleave(x, n, dim=axis))(k_cache, rep, axis=1)
        v = (lambda x, n, axis: torch.repeat_interleave(x, n, dim=axis))(v_cache, rep, axis=1)
        scores = torch.einsum("bhqd,bhkd->bhqk", q, k) * (Dh ** -0.5)
        p = _softmax(scores, axis=-1)
        o = torch.einsum("bhqk,bhkd->bhqd", p, v)
        return (lambda x, *d: x.permute(*d))(o, 0, 2, 1, 3).reshape(B, Sq, Hq * Dh) @ wo

    def _B_ref(x, w_gate, w_up, w_down):
        g = torch.einsum("bsd,df->bsf", x, w_gate)
        u = torch.einsum("bsd,df->bsf", x, w_up)
        h = _gelu(g) * u
        return torch.einsum("bsf,fd->bsd", h, w_down)

    x = A_x
    xn = _layernorm(x, axis=-1)
    s = _A_ref(xn, A_k_cache, A_v_cache, A_wq, A_wo)
    g = _silu(_B_ref(xn, B_w_gate, B_w_up, B_w_down))
    return x + s * g
```

```asm
; @launch grid=(256,1,1) block=(512,1,1) lds=160256
.amdgcn_target "amdgcn-amd-amdhsa--gfx950"
.text
.globl recurrent_scan__gqa_block_cached__glu_gated_geglu__decode_kernel
.p2align 8
.type recurrent_scan__gqa_block_cached__glu_gated_geglu__decode_kernel,@function
recurrent_scan__gqa_block_cached__glu_gated_geglu__decode_kernel:
s_cmp_ge_u32 s2, 256
s_cbranch_scc1 L_end
s_load_dwordx8 s[4:11], s[0:1], 0
s_load_dwordx8 s[12:19], s[0:1], 32
s_load_dwordx8 s[20:27], s[0:1], 64
v_and_b32 v1, 63, v0
v_lshrrev_b32 v2, 6, v0
v_lshlrev_b32 v3, 2, v1
v_add_u32 v3, 147456, v3
v_mov_b32 v4, 0
ds_write_b32 v3, v4
v_readfirstlane_b32 s3, v2
s_mov_b32 s45, 1048576
s_mov_b32 s40, 0
s_mov_b32 s43, 0
s_mov_b32 s73, 0

v_lshrrev_b32 v5, 5, v1
v_and_b32 v6, 31, v1
v_xor_b32 v6, v6, v5
v_lshlrev_b32 v5, 9, v5
v_xor_b32 v7, 0, v6
v_lshl_add_u32 v8, v7, 4, v5
v_xor_b32 v7, 2, v6
v_lshl_add_u32 v9, v7, 4, v5
v_xor_b32 v7, 4, v6
v_lshl_add_u32 v10, v7, 4, v5
v_xor_b32 v7, 6, v6
v_lshl_add_u32 v11, v7, 4, v5
v_xor_b32 v7, 8, v6
v_lshl_add_u32 v12, v7, 4, v5
v_xor_b32 v7, 10, v6
v_lshl_add_u32 v13, v7, 4, v5
v_xor_b32 v7, 12, v6
v_lshl_add_u32 v14, v7, 4, v5
v_xor_b32 v7, 14, v6
v_lshl_add_u32 v15, v7, 4, v5
v_lshlrev_b32 v16, 4, v1
v_mov_b32 v17, 147456
s_lshr_b32 s46, s2, 4
s_lshl_b32 s46, s46, 24
s_mov_b32 s41, 0
s_and_b32 s66, s2, 15
s_mov_b32 s67, 0
s_mov_b32 s44, 0
s_lshr_b32 s70, s2, 4
s_mul_i32 s68, s70, 43
s_lshl_b32 s69, s67, 1
s_add_u32 s42, s69, s68
s_and_b32 s42, s42, 255
s_lshl_b32 s42, s42, 16
s_mul_i32 s69, s69, 5
s_add_u32 s69, s69, s66
s_and_b32 s69, s69, 15
s_lshl_b32 s75, s69, 12
s_mov_b32 s53, 0
s_mov_b32 s30, 16777216
s_mov_b32 s31, 0x20000
s_mov_b32 s34, 16777216
s_mov_b32 s35, 0x20000
s_waitcnt lgkmcnt(0)
s_add_u32 s28, s6, s46
s_addc_u32 s29, s7, 0
s_and_b32 s29, s29, 0xffff
s_barrier
s_cmp_lg_u32 s3, 0
s_cbranch_scc1 L_notloader
s_setprio 3
s_add_u32 m0, s41, 0
s_or_b32 s47, s42, s75
buffer_load_dwordx4 v8, s[28:31], s47 offen offset:0 nt lds
s_add_u32 s42, s42, 0x10000
s_and_b32 s42, s42, 0xffffff
s_add_u32 s75, s75, 20480
s_and_b32 s75, s75, 0xffff
buffer_load_dwordx4 v9, s[28:31], s47 offen offset:1024 nt lds
buffer_load_dwordx4 v10, s[28:31], s47 offen offset:2048 nt lds
buffer_load_dwordx4 v11, s[28:31], s47 offen offset:3072 nt lds
s_add_u32 m0, s41, 4096
s_or_b32 s47, s42, s75
buffer_load_dwordx4 v12, s[28:31], s47 offen offset:0 nt lds
s_add_u32 s42, s42, 0x10000
s_and_b32 s42, s42, 0xffffff
s_add_u32 s75, s75, 20480
s_and_b32 s75, s75, 0xffff
buffer_load_dwordx4 v13, s[28:31], s47 offen offset:1024 nt lds
buffer_load_dwordx4 v14, s[28:31], s47 offen offset:2048 nt lds
buffer_load_dwordx4 v15, s[28:31], s47 offen offset:3072 nt lds
s_add_u32 m0, s41, 8192
s_or_b32 s47, s42, s75
s_add_u32 s44, s44, 4
s_cmp_ge_u32 s44, 36
s_cselect_b32 s44, 0, s44
v_add_u32 v19, s44, v17
ds_read_b32 v20, v19 offset:64
buffer_load_dwordx4 v8, s[28:31], s47 offen offset:0 nt lds
s_add_u32 s42, s42, 0x10000
s_and_b32 s42, s42, 0xffffff
s_add_u32 s75, s75, 20480
s_and_b32 s75, s75, 0xffff
buffer_load_dwordx4 v9, s[28:31], s47 offen offset:1024 nt lds
buffer_load_dwordx4 v10, s[28:31], s47 offen offset:2048 nt lds
buffer_load_dwordx4 v11, s[28:31], s47 offen offset:3072 nt lds
s_add_u32 m0, s41, 12288
s_or_b32 s47, s42, s75
buffer_load_dwordx4 v12, s[28:31], s47 offen offset:0 nt lds
s_add_u32 s42, s42, 0x10000
s_and_b32 s42, s42, 0xffffff
s_add_u32 s75, s75, 20480
s_and_b32 s75, s75, 0xffff
buffer_load_dwordx4 v13, s[28:31], s47 offen offset:1024 nt lds
buffer_load_dwordx4 v14, s[28:31], s47 offen offset:2048 nt lds
buffer_load_dwordx4 v15, s[28:31], s47 offen offset:3072 nt lds
s_add_u32 s40, s40, 1
s_add_u32 s41, s41, 16384
s_cmp_ge_u32 s41, 147456
s_cselect_b32 s41, 0, s41
s_sub_u32 s53, s53, 1
s_add_u32 s32, s8, s46
s_addc_u32 s33, s9, 0
s_and_b32 s33, s33, 0xffff
s_mul_i32 s50, s70, 4352
s_add_u32 s50, s50, 4096
s_add_u32 s56, s26, s50
s_addc_u32 s57, s27, 0
s_mov_b32 s60, 0x10203
s_mov_b32 s61, 0x0
s_mov_b32 s62, 0x7f7d7a
s_mov_b32 s63, 0x0
s_mov_b32 s54, 0
s_cmp_lt_u32 s70, 14
s_cselect_b32 s71, 1, 0
s_add_u32 s72, s66, 106
s_cmp_eq_u32 s66, s70
s_cselect_b32 s78, s71, 0
s_mul_i32 s78, s78, 14
s_sub_u32 s78, 61, s78
s_mul_i32 s80, s71, 2
s_sub_u32 s53, s78, 1
s_branch L_ld_kbot
L_ld_k:
s_add_u32 m0, s41, 0
s_or_b32 s47, s42, s75
s_waitcnt vmcnt(19)
buffer_load_dwordx4 v8, s[28:31], s47 offen offset:0 nt lds
s_add_u32 s42, s42, 0x10000
s_and_b32 s42, s42, 0xffffff
s_add_u32 s75, s75, 20480
s_and_b32 s75, s75, 0xffff
s_waitcnt vmcnt(19)
buffer_load_dwordx4 v9, s[28:31], s47 offen offset:1024 nt lds
s_waitcnt vmcnt(19)
buffer_load_dwordx4 v10, s[28:31], s47 offen offset:2048 nt lds
s_waitcnt vmcnt(19)
buffer_load_dwordx4 v11, s[28:31], s47 offen offset:3072 nt lds
s_sub_i32 s49, s40, 1
s_max_i32 s43, s43, s49
v_mov_b32 v18, s43
ds_write_b32 v17, v18
s_add_u32 m0, s41, 4096
s_or_b32 s47, s42, s75
s_waitcnt vmcnt(19)
buffer_load_dwordx4 v12, s[28:31], s47 offen offset:0 nt lds
s_add_u32 s42, s42, 0x10000
s_and_b32 s42, s42, 0xffffff
s_add_u32 s75, s75, 20480
s_and_b32 s75, s75, 0xffff
s_waitcnt vmcnt(19)
buffer_load_dwordx4 v13, s[28:31], s47 offen offset:1024 nt lds
s_waitcnt vmcnt(19)
buffer_load_dwordx4 v14, s[28:31], s47 offen offset:2048 nt lds
s_waitcnt vmcnt(19)
buffer_load_dwordx4 v15, s[28:31], s47 offen offset:3072 nt lds
s_add_u32 m0, s41, 8192
s_or_b32 s47, s42, s75
s_add_u32 s44, s44, 4
s_cmp_ge_u32 s44, 36
s_cselect_b32 s44, 0, s44
v_add_u32 v19, s44, v17
ds_read_b32 v20, v19 offset:64
s_waitcnt vmcnt(19)
buffer_load_dwordx4 v8, s[28:31], s47 offen offset:0 nt lds
s_add_u32 s42, s42, 0x10000
s_and_b32 s42, s42, 0xffffff
s_add_u32 s75, s75, 20480
s_and_b32 s75, s75, 0xffff
s_waitcnt vmcnt(19)
buffer_load_dwordx4 v9, s[28:31], s47 offen offset:1024 nt lds
s_waitcnt vmcnt(19)
buffer_load_dwordx4 v10, s[28:31], s47 offen offset:2048 nt lds
s_waitcnt vmcnt(19)
buffer_load_dwordx4 v11, s[28:31], s47 offen offset:3072 nt lds
s_add_u32 m0, s41, 12288
s_or_b32 s47, s42, s75
s_waitcnt vmcnt(19)
buffer_load_dwordx4 v12, s[28:31], s47 offen offset:0 nt lds
s_add_u32 s42, s42, 0x10000
s_and_b32 s42, s42, 0xffffff
s_add_u32 s75, s75, 20480
s_and_b32 s75, s75, 0xffff
s_waitcnt vmcnt(19)
buffer_load_dwordx4 v13, s[28:31], s47 offen offset:1024 nt lds
s_waitcnt vmcnt(19)
buffer_load_dwordx4 v14, s[28:31], s47 offen offset:2048 nt lds
s_waitcnt vmcnt(19)
buffer_load_dwordx4 v15, s[28:31], s47 offen offset:3072 nt lds
s_add_u32 s40, s40, 1
s_add_u32 s41, s41, 16384
s_cmp_ge_u32 s41, 147456
s_cselect_b32 s41, 0, s41
s_sub_u32 s53, s53, 1
L_ld_kbot:
s_add_u32 s67, s67, 2
s_cmp_lg_u32 s53, 0
s_cbranch_scc1 L_ld_kc
s_mov_b32 s67, 0
s_mov_b32 s53, s78
s_branch L_ld_vc
L_ld_kc:
s_waitcnt lgkmcnt(0)
s_sub_i32 s48, s40, 8
v_readfirstlane_b32 s47, v20
s_cmp_ge_i32 s47, s48
s_cbranch_scc1 L_ld_k
s_waitcnt vmcnt(0)
s_mov_b32 s43, s40
v_mov_b32 v18, s43
ds_write_b32 v17, v18
L_ld_k_spin:
ds_read_b32 v20, v19 offset:64
s_waitcnt lgkmcnt(0)
v_readfirstlane_b32 s47, v20
s_cmp_ge_i32 s47, s48
s_cbranch_scc1 L_ld_k
s_sleep 1
s_sub_u32 s45, s45, 1
s_cmp_lg_u32 s45, 0
s_cbranch_scc1 L_ld_k_spin
s_endpgm
L_ld_v:
s_add_u32 s74, s53, s71
s_cmp_lg_u32 s74, 1
s_cbranch_scc1 L_noat_1
s_mov_b32 s54, 1
s_atomic_add s54, s[56:57], 0x0 glc
L_noat_1:
s_add_u32 m0, s41, 0
s_or_b32 s47, s42, s75
s_waitcnt vmcnt(19)
buffer_load_dwordx4 v16, s[32:35], s47 offen offset:0 nt lds
s_add_u32 s42, s42, 0x10000
s_and_b32 s42, s42, 0xffffff
s_add_u32 s75, s75, 20480
s_and_b32 s75, s75, 0xffff
s_waitcnt vmcnt(19)
buffer_load_dwordx4 v16, s[32:35], s47 offen offset:1024 nt lds
s_waitcnt vmcnt(19)
buffer_load_dwordx4 v16, s[32:35], s47 offen offset:2048 nt lds
s_waitcnt vmcnt(19)
buffer_load_dwordx4 v16, s[32:35], s47 offen offset:3072 nt lds
s_sub_i32 s49, s40, 1
s_max_i32 s43, s43, s49
v_mov_b32 v18, s43
ds_write_b32 v17, v18
s_add_u32 m0, s41, 4096
s_or_b32 s47, s42, s75
s_waitcnt vmcnt(19)
buffer_load_dwordx4 v16, s[32:35], s47 offen offset:0 nt lds
s_add_u32 s42, s42, 0x10000
s_and_b32 s42, s42, 0xffffff
s_add_u32 s75, s75, 20480
s_and_b32 s75, s75, 0xffff
s_waitcnt vmcnt(19)
buffer_load_dwordx4 v16, s[32:35], s47 offen offset:1024 nt lds
s_waitcnt vmcnt(19)
buffer_load_dwordx4 v16, s[32:35], s47 offen offset:2048 nt lds
s_waitcnt vmcnt(19)
buffer_load_dwordx4 v16, s[32:35], s47 offen offset:3072 nt lds
s_add_u32 m0, s41, 8192
s_or_b32 s47, s42, s75
s_add_u32 s44, s44, 4
s_cmp_ge_u32 s44, 36
s_cselect_b32 s44, 0, s44
v_add_u32 v19, s44, v17
ds_read_b32 v20, v19 offset:64
s_waitcnt vmcnt(19)
buffer_load_dwordx4 v16, s[32:35], s47 offen offset:0 nt lds
s_add_u32 s42, s42, 0x10000
s_and_b32 s42, s42, 0xffffff
s_add_u32 s75, s75, 20480
s_and_b32 s75, s75, 0xffff
s_waitcnt vmcnt(19)
buffer_load_dwordx4 v16, s[32:35], s47 offen offset:1024 nt lds
s_waitcnt vmcnt(19)
buffer_load_dwordx4 v16, s[32:35], s47 offen offset:2048 nt lds
s_waitcnt vmcnt(19)
buffer_load_dwordx4 v16, s[32:35], s47 offen offset:3072 nt lds
s_add_u32 m0, s41, 12288
s_or_b32 s47, s42, s75
s_waitcnt vmcnt(19)
buffer_load_dwordx4 v16, s[32:35], s47 offen offset:0 nt lds
s_add_u32 s42, s42, 0x10000
s_and_b32 s42, s42, 0xffffff
s_add_u32 s75, s75, 20480
s_and_b32 s75, s75, 0xffff
s_waitcnt vmcnt(19)
buffer_load_dwordx4 v16, s[32:35], s47 offen offset:1024 nt lds
s_waitcnt vmcnt(19)
buffer_load_dwordx4 v16, s[32:35], s47 offen offset:2048 nt lds
s_waitcnt vmcnt(19)
buffer_load_dwordx4 v16, s[32:35], s47 offen offset:3072 nt lds
s_add_u32 s40, s40, 1
s_add_u32 s41, s41, 16384
s_cmp_ge_u32 s41, 147456
s_cselect_b32 s41, 0, s41
s_sub_u32 s53, s53, 1
s_add_u32 s67, s67, 2
s_cmp_eq_u32 s53, 0
s_cbranch_scc1 L_ld_next
L_ld_vc:
s_lshl_b32 s69, s67, 1
s_add_u32 s42, s69, s68
s_and_b32 s42, s42, 255
s_lshl_b32 s42, s42, 16
s_mul_i32 s69, s69, 5
s_add_u32 s69, s69, s66
s_and_b32 s69, s69, 15
s_lshl_b32 s75, s69, 12
s_waitcnt lgkmcnt(0)
s_sub_i32 s48, s40, 8
v_readfirstlane_b32 s47, v20
s_cmp_ge_i32 s47, s48
s_cbranch_scc1 L_ld_v
s_waitcnt vmcnt(0)
s_mov_b32 s43, s40
v_mov_b32 v18, s43
ds_write_b32 v17, v18
L_ld_v_spin:
ds_read_b32 v20, v19 offset:64
s_waitcnt lgkmcnt(0)
v_readfirstlane_b32 s47, v20
s_cmp_ge_i32 s47, s48
s_cbranch_scc1 L_ld_v
s_sleep 1
s_sub_u32 s45, s45, 1
s_cmp_lg_u32 s45, 0
s_cbranch_scc1 L_ld_v_spin
s_endpgm
L_ld_c:
s_add_u32 s74, s53, s71
s_cmp_lg_u32 s74, 1
s_cbranch_scc1 L_noat_2
s_mov_b32 s54, 1
s_atomic_add s54, s[56:57], 0x0 glc
L_noat_2:
s_add_u32 m0, s41, 0
s_or_b32 s47, s42, s75
s_mov_b32 s76, s47
s_waitcnt vmcnt(31)
buffer_load_dwordx4 v8, s[28:31], s47 offen offset:0 nt lds
s_add_u32 s42, s42, 0x10000
s_and_b32 s42, s42, 0xffffff
s_add_u32 s75, s75, 20480
s_and_b32 s75, s75, 0xffff
s_waitcnt vmcnt(31)
buffer_load_dwordx4 v9, s[28:31], s47 offen offset:1024 nt lds
s_waitcnt vmcnt(31)
buffer_load_dwordx4 v10, s[28:31], s47 offen offset:2048 nt lds
s_waitcnt vmcnt(31)
buffer_load_dwordx4 v11, s[28:31], s47 offen offset:3072 nt lds
s_add_u32 m0, s41, 4096
s_or_b32 s47, s42, s75
s_mov_b32 s77, s47
s_waitcnt vmcnt(31)
buffer_load_dwordx4 v12, s[28:31], s47 offen offset:0 nt lds
s_add_u32 s42, s42, 0x10000
s_and_b32 s42, s42, 0xffffff
s_add_u32 s75, s75, 20480
s_and_b32 s75, s75, 0xffff
s_waitcnt vmcnt(31)
buffer_load_dwordx4 v13, s[28:31], s47 offen offset:1024 nt lds
s_waitcnt vmcnt(31)
buffer_load_dwordx4 v14, s[28:31], s47 offen offset:2048 nt lds
s_waitcnt vmcnt(31)
buffer_load_dwordx4 v15, s[28:31], s47 offen offset:3072 nt lds
s_add_u32 m0, s41, 8192
s_mov_b32 s47, s76
s_add_u32 s44, s44, 4
s_cmp_ge_u32 s44, 36
s_cselect_b32 s44, 0, s44
v_add_u32 v19, s44, v17
ds_read_b32 v20, v19 offset:64
s_waitcnt vmcnt(31)
buffer_load_dwordx4 v16, s[32:35], s47 offen offset:0 nt lds
s_waitcnt vmcnt(31)
buffer_load_dwordx4 v16, s[32:35], s47 offen offset:1024 nt lds
s_waitcnt vmcnt(31)
buffer_load_dwordx4 v16, s[32:35], s47 offen offset:2048 nt lds
s_waitcnt vmcnt(31)
buffer_load_dwordx4 v16, s[32:35], s47 offen offset:3072 nt lds
s_add_u32 m0, s41, 12288
s_mov_b32 s47, s77
s_waitcnt vmcnt(31)
buffer_load_dwordx4 v16, s[32:35], s47 offen offset:0 nt lds
s_waitcnt vmcnt(31)
buffer_load_dwordx4 v16, s[32:35], s47 offen offset:1024 nt lds
s_waitcnt vmcnt(31)
buffer_load_dwordx4 v16, s[32:35], s47 offen offset:2048 nt lds
s_waitcnt vmcnt(31)
buffer_load_dwordx4 v16, s[32:35], s47 offen offset:3072 nt lds
s_sub_i32 s49, s40, 1
s_max_i32 s43, s43, s49
v_mov_b32 v18, s43
ds_write_b32 v17, v18
s_add_u32 s40, s40, 1
s_add_u32 s41, s41, 16384
s_cmp_ge_u32 s41, 147456
s_cselect_b32 s41, 0, s41
s_sub_u32 s53, s53, 1
s_add_u32 s67, s67, 1
s_cmp_lg_u32 s53, 0
s_cbranch_scc1 L_ld_cc
L_ld_next:
s_cmp_eq_u32 s71, 0
s_cbranch_scc1 L_ld_tick
s_mov_b32 s71, 0
s_mov_b32 s53, 1
s_mov_b32 s66, s70
s_mov_b32 s67, s72
s_branch L_ld_cc
L_ld_tick:
s_waitcnt lgkmcnt(0)
s_cmp_ge_u32 s54, s80
s_cbranch_scc1 L_ld_tick2
s_mov_b32 s53, 6
s_mov_b32 s66, s70
s_mul_i32 s67, s54, 6
s_add_u32 s67, s67, 94
s_branch L_ld_cc
L_ld_tick2:
s_sub_u32 s54, s54, s80
s_cmp_ge_u32 s54, 48
s_cbranch_scc1 L_ld_done
s_lshr_b32 s51, s54, 4
s_lshl_b32 s51, s51, 3
s_lshr_b64 s[64:65], s[60:61], s51
s_and_b32 s53, s64, 0xff
s_lshr_b64 s[64:65], s[62:63], s51
s_and_b32 s67, s64, 0xff
s_and_b32 s66, s54, 15
L_ld_cc:
s_lshl_b32 s69, s67, 1
s_add_u32 s42, s69, s68
s_and_b32 s42, s42, 255
s_lshl_b32 s42, s42, 16
s_mul_i32 s69, s69, 5
s_add_u32 s69, s69, s66
s_and_b32 s69, s69, 15
s_lshl_b32 s75, s69, 12
s_waitcnt lgkmcnt(0)
s_sub_i32 s48, s40, 8
v_readfirstlane_b32 s47, v20
s_cmp_ge_i32 s47, s48
s_cbranch_scc1 L_ld_c
s_waitcnt vmcnt(0)
s_mov_b32 s43, s40
v_mov_b32 v18, s43
ds_write_b32 v17, v18
L_ld_c_spin:
ds_read_b32 v20, v19 offset:64
s_waitcnt lgkmcnt(0)
v_readfirstlane_b32 s47, v20
s_cmp_ge_i32 s47, s48
s_cbranch_scc1 L_ld_c
s_sleep 1
s_sub_u32 s45, s45, 1
s_cmp_lg_u32 s45, 0
s_cbranch_scc1 L_ld_c_spin
s_endpgm
L_ld_done:
s_lshl_b32 s50, s40, 16
s_or_b32 s51, s50, s43
v_mov_b32 v18, s51
ds_write_b32 v17, v18
s_sub_u32 s51, s40, 1
s_max_u32 s51, s51, s43
s_or_b32 s51, s51, s50
s_waitcnt vmcnt(16)
v_mov_b32 v18, s51
ds_write_b32 v17, v18
s_or_b32 s51, s51, 0x8000
s_waitcnt vmcnt(8)
v_mov_b32 v18, s51
ds_write_b32 v17, v18
s_sub_u32 s51, s40, 0
s_max_u32 s51, s51, s43
s_or_b32 s51, s51, s50
s_waitcnt vmcnt(0)
v_mov_b32 v18, s51
ds_write_b32 v17, v18
s_endpgm
L_notloader:
s_load_dword s58, s[26:27], 0
s_mov_b32 s59, 15
v_and_b32 v3, 7, v1
v_lshrrev_b32 v4, 1, v3
v_and_b32 v5, 1, v3
v_mov_b32 v6, 0x0c0c0100
v_mov_b32 v7, 0x01000c0c
v_cmp_eq_u32 vcc, 1, v5
v_mov_b32 v8, 0x0c0c0302
v_mov_b32 v9, 0x03020c0c
v_cndmask_b32 v6, v6, v7, vcc
v_cndmask_b32 v8, v8, v9, vcc
v_mov_b32 v7, 0x0c0c0c0c
v_cmp_eq_u32 vcc, 0, v4
s_nop 1
v_cndmask_b32 v12, v7, v6, vcc
v_cndmask_b32 v16, v7, v8, vcc
v_cmp_eq_u32 vcc, 1, v4
s_nop 1
v_cndmask_b32 v13, v7, v6, vcc
v_cndmask_b32 v17, v7, v8, vcc
v_cmp_eq_u32 vcc, 2, v4
s_nop 1
v_cndmask_b32 v14, v7, v6, vcc
v_cndmask_b32 v18, v7, v8, vcc
v_cmp_eq_u32 vcc, 3, v4
s_nop 1
v_cndmask_b32 v15, v7, v6, vcc
v_cndmask_b32 v19, v7, v8, vcc
v_and_b32 v10, 15, v1
v_lshrrev_b32 v11, 4, v1
s_lshr_b32 s50, s2, 4
s_and_b32 s51, s2, 15
s_lshr_b32 s52, s2, 7
s_and_b32 s53, s50, 7
s_mov_b32 s54, 0x3db8aa3b
s_mov_b32 s36, s26
s_and_b32 s37, s27, 0xffff
s_mov_b32 s38, 4194304
s_mov_b32 s39, 0x20000
s_cmp_eq_u32 s3, 4
s_cbranch_scc1 L_helper
s_sub_u32 s55, s3, 1
s_cmp_gt_u32 s3, 4
s_cselect_b32 s47, 1, 0
s_sub_u32 s55, s55, s47
s_mov_b32 s28, s12
s_and_b32 s29, s13, 0xffff
s_mov_b32 s30, 3670016
s_mov_b32 s31, 0x20000
s_lshl_b32 s82, s53, 9
s_lshl_b32 s47, s51, 5
s_add_u32 s82, s82, s47
s_mul_i32 s82, s82, 896
s_lshl_b32 s47, s55, 8
s_add_u32 s82, s82, s47
v_mul_u32_u24 v204, 896, v11
v_lshl_add_u32 v204, v10, 4, v204
s_cmp_eq_u32 s55, 3
s_cselect_b32 s47, 8, 16
v_cmp_le_u32 vcc, s47, v10
v_bfrev_b32 v205, 2
s_nop 0
v_cndmask_b32 v204, v204, v205, vcc
L_c_nowo:
v_xor_b32 v23, v10, v11
v_lshlrev_b32 v24, 9, v10
v_xor_b32 v25, 0, v23
v_lshl_add_u32 v2, v25, 4, v24
v_xor_b32 v25, 4, v23
v_lshl_add_u32 v3, v25, 4, v24
v_xor_b32 v25, 8, v23
v_lshl_add_u32 v4, v25, 4, v24
v_xor_b32 v25, 12, v23
v_lshl_add_u32 v5, v25, 4, v24
v_lshlrev_b32 v24, 11, v11
v_lshl_add_u32 v6, v10, 4, v24
v_mov_b32 v188, 147456
v_mov_b32 v20, 0xff61b1e6
v_mul_f32 v21, s54, v20
v_mov_b32 v22, 0
v_mov_b32 v132, 0
v_mov_b32 v133, 0
v_mov_b32 v134, 0
v_mov_b32 v135, 0
v_mov_b32 v136, 0
v_mov_b32 v137, 0
v_mov_b32 v138, 0
v_mov_b32 v139, 0
v_mov_b32 v189, v10
v_mov_b32 v190, v11
v_lshrrev_b32 v23, 3, v10
v_lshlrev_b32 v23, 6, v23
v_lshl_add_u32 v23, v11, 4, v23
v_add_u32 v202, 151040, v23
s_cmp_lt_u32 s50, 14
s_cselect_b32 s78, 14, 0
s_cmp_eq_u32 s51, s50
s_cselect_b32 s78, s78, 0
s_sub_u32 s78, 61, s78
s_lshl_b32 s79, s78, 1
s_mov_b32 s40, s55
s_lshl_b32 s41, s55, 14
s_mov_b32 s44, 0
s_waitcnt lgkmcnt(0)
s_add_u32 s58, s58, 0x1111
s_bfe_u32 s46, s58, 0x40000
v_mov_b32 v212, s46
s_bfe_u32 s46, s58, 0x40004
v_mov_b32 v213, s46
s_bfe_u32 s46, s58, 0x40008
v_mov_b32 v214, s46
s_bfe_u32 s46, s58, 0x4000c
v_mov_b32 v215, s46
L_ck:
ds_read_b32 v23, v188
s_lshr_b32 s47, s41, 12
v_add_u32 v191, s47, v188
s_add_u32 s42, s40, 1
v_mov_b32 v192, s42
s_waitcnt lgkmcnt(0)
v_readfirstlane_b32 s43, v23
s_and_b32 s46, s43, 0x7fff
s_cmp_gt_u32 s46, s40
s_cbranch_scc1 L_ck_go
s_sleep 1
s_sub_u32 s45, s45, 1
s_cmp_lg_u32 s45, 0
s_cbranch_scc1 L_ck
s_endpgm
L_ck_go:
v_add_u32 v7, s41, v2
v_add_u32 v8, s41, v3
v_add_u32 v9, s41, v4
v_add_u32 v10, s41, v5
ds_read_b128 v[64:67], v7 offset:0
ds_read_b128 v[68:71], v8 offset:0
ds_read_b128 v[72:75], v9 offset:0
ds_read_b128 v[76:79], v10 offset:0
ds_read_b128 v[80:83], v7 offset:256
ds_read_b128 v[84:87], v8 offset:256
ds_read_b128 v[88:91], v9 offset:256
ds_read_b128 v[92:95], v10 offset:256
ds_read_b128 v[96:99], v7 offset:8192
ds_read_b128 v[100:103], v8 offset:8192
ds_read_b128 v[104:107], v9 offset:8192
ds_read_b128 v[108:111], v10 offset:8192
ds_read_b128 v[112:115], v7 offset:8448
ds_read_b128 v[116:119], v8 offset:8448
ds_read_b128 v[120:123], v9 offset:8448
ds_read_b128 v[124:127], v10 offset:8448
s_lshl_b32 s47, s40, 7
v_add_u32 v203, s47, v202
s_waitcnt lgkmcnt(0)
ds_write_b32 v191, v192 offset:64
s_cmp_eq_u32 s44, 0
s_cbranch_scc1 L_c_first
L_ck_comp:
v_mfma_f32_16x16x32_bf16 v[128:131], v[64:67], v[32:35], 0
v_mfma_f32_16x16x32_bf16 v[140:143], v[96:99], v[32:35], 0
v_mfma_f32_16x16x32_bf16 v[128:131], v[68:71], v[36:39], v[128:131]
v_mfma_f32_16x16x32_bf16 v[140:143], v[100:103], v[36:39], v[140:143]
v_mfma_f32_16x16x32_bf16 v[128:131], v[72:75], v[40:43], v[128:131]
v_mfma_f32_16x16x32_bf16 v[140:143], v[104:107], v[40:43], v[140:143]
v_mfma_f32_16x16x32_bf16 v[128:131], v[76:79], v[44:47], v[128:131]
v_mfma_f32_16x16x32_bf16 v[140:143], v[108:111], v[44:47], v[140:143]
v_mfma_f32_16x16x32_bf16 v[128:131], v[80:83], v[48:51], v[128:131]
v_mfma_f32_16x16x32_bf16 v[140:143], v[112:115], v[48:51], v[140:143]
v_mfma_f32_16x16x32_bf16 v[128:131], v[84:87], v[52:55], v[128:131]
v_mfma_f32_16x16x32_bf16 v[140:143], v[116:119], v[52:55], v[140:143]
v_mfma_f32_16x16x32_bf16 v[128:131], v[88:91], v[56:59], v[128:131]
v_mfma_f32_16x16x32_bf16 v[140:143], v[120:123], v[56:59], v[140:143]
v_mfma_f32_16x16x32_bf16 v[128:131], v[92:95], v[60:63], v[128:131]
v_mfma_f32_16x16x32_bf16 v[140:143], v[124:127], v[60:63], v[140:143]
s_add_u32 s40, s40, 6
s_add_u32 s41, s41, 98304
s_sub_u32 s47, s41, 147456
s_cmp_ge_u32 s41, 147456
s_cselect_b32 s41, s47, s41
s_nop 2
v_cvt_pk_bf16_f32 v24, v128, v129
v_cvt_pk_bf16_f32 v25, v130, v131
v_cvt_pk_bf16_f32 v26, v140, v141
v_cvt_pk_bf16_f32 v27, v142, v143
s_mov_b32 exec_lo, 0x01010101
s_mov_b32 exec_hi, 0x01010101
ds_write_b128 v203, v[24:27]
s_mov_b64 exec, -1
s_cmp_lt_u32 s40, s78
s_cbranch_scc1 L_ck
L_cv:
ds_read_b32 v23, v188
s_lshr_b32 s47, s41, 12
v_add_u32 v191, s47, v188
s_add_u32 s42, s40, 1
v_mov_b32 v192, s42
s_waitcnt lgkmcnt(0)
v_readfirstlane_b32 s43, v23
s_and_b32 s46, s43, 0x7fff
s_cmp_gt_u32 s46, s40
s_cbranch_scc1 L_cv_go
s_sleep 1
s_sub_u32 s45, s45, 1
s_cmp_lg_u32 s45, 0
s_cbranch_scc1 L_cv
s_endpgm
L_cv_go:
s_sub_u32 s47, s40, s78
s_lshl_b32 s47, s47, 7
v_add_u32 v203, s47, v202
v_add_u32 v11, s41, v6
ds_read_b128 v[24:27], v203
ds_read_b128 v[64:67], v11 offset:0
ds_read_b128 v[68:71], v11 offset:256
ds_read_b128 v[72:75], v11 offset:512
ds_read_b128 v[76:79], v11 offset:768
ds_read_b128 v[80:83], v11 offset:1024
ds_read_b128 v[84:87], v11 offset:1280
ds_read_b128 v[88:91], v11 offset:1536
ds_read_b128 v[92:95], v11 offset:1792
ds_read_b128 v[96:99], v11 offset:8192
ds_read_b128 v[100:103], v11 offset:8448
ds_read_b128 v[104:107], v11 offset:8704
ds_read_b128 v[108:111], v11 offset:8960
ds_read_b128 v[112:115], v11 offset:9216
ds_read_b128 v[116:119], v11 offset:9472
s_waitcnt lgkmcnt(14)
ds_read_b128 v[120:123], v11 offset:9728
ds_read_b128 v[124:127], v11 offset:9984
v_lshlrev_b32 v194, 16, v24
v_and_b32 v195, 0xffff0000, v24
v_lshlrev_b32 v196, 16, v25
v_and_b32 v197, 0xffff0000, v25
v_lshlrev_b32 v198, 16, v26
v_and_b32 v199, 0xffff0000, v26
v_lshlrev_b32 v200, 16, v27
v_and_b32 v201, 0xffff0000, v27
v_max3_f32 v30, v194, v195, v196
v_max3_f32 v31, v197, v198, v199
v_max3_f32 v30, v30, v200, v201
v_max_f32 v30, v30, v31
v_cmp_gt_f32 vcc, v30, v20
s_cbranch_vccnz L_cv_resc
L_cv_resc_ret:
v_fma_f32 v194, v194, s54, -v21
v_fma_f32 v195, v195, s54, -v21
v_fma_f32 v196, v196, s54, -v21
v_fma_f32 v197, v197, s54, -v21
v_fma_f32 v198, v198, s54, -v21
v_fma_f32 v199, v199, s54, -v21
v_fma_f32 v200, v200, s54, -v21
v_fma_f32 v201, v201, s54, -v21
v_exp_f32 v194, v194
v_exp_f32 v195, v195
v_exp_f32 v196, v196
v_exp_f32 v197, v197
v_exp_f32 v198, v198
v_exp_f32 v199, v199
v_exp_f32 v200, v200
v_exp_f32 v201, v201
s_nop 0
v_cvt_pk_bf16_f32 v24, v194, v195
v_cvt_pk_bf16_f32 v25, v196, v197
v_cvt_pk_bf16_f32 v26, v198, v199
v_cvt_pk_bf16_f32 v27, v200, v201
v_add_f32 v194, v194, v195
v_add_f32 v196, v196, v197
v_add_f32 v198, v198, v199
v_add_f32 v200, v200, v201
v_add_f32 v194, v194, v196
v_add_f32 v198, v198, v200
v_add_f32 v22, v22, v194
v_add_f32 v22, v22, v198
s_waitcnt lgkmcnt(0)
ds_write_b32 v191, v192 offset:64
v_perm_b32 v140, v24, v24, v12
v_perm_b32 v141, v24, v24, v13
v_perm_b32 v142, v24, v24, v14
v_perm_b32 v143, v24, v24, v15
v_perm_b32 v144, v24, v24, v16
v_perm_b32 v145, v24, v24, v17
v_perm_b32 v146, v24, v24, v18
v_perm_b32 v147, v24, v24, v19
v_mfma_f32_16x16x32_bf16 v[132:135], v[64:67], v[140:143], v[132:135]
v_mfma_f32_16x16x32_bf16 v[136:139], v[68:71], v[140:143], v[136:139]
v_perm_b32 v148, v25, v25, v12
v_perm_b32 v149, v25, v25, v13
v_perm_b32 v150, v25, v25, v14
v_perm_b32 v151, v25, v25, v15
v_mfma_f32_16x16x32_bf16 v[132:135], v[72:75], v[144:147], v[132:135]
v_mfma_f32_16x16x32_bf16 v[136:139], v[76:79], v[144:147], v[136:139]
v_perm_b32 v152, v25, v25, v16
v_perm_b32 v153, v25, v25, v17
v_perm_b32 v154, v25, v25, v18
v_perm_b32 v155, v25, v25, v19
v_mfma_f32_16x16x32_bf16 v[132:135], v[80:83], v[148:151], v[132:135]
v_mfma_f32_16x16x32_bf16 v[136:139], v[84:87], v[148:151], v[136:139]
v_perm_b32 v140, v26, v26, v12
v_perm_b32 v141, v26, v26, v13
v_perm_b32 v142, v26, v26, v14
v_perm_b32 v143, v26, v26, v15
v_mfma_f32_16x16x32_bf16 v[132:135], v[88:91], v[152:155], v[132:135]
v_mfma_f32_16x16x32_bf16 v[136:139], v[92:95], v[152:155], v[136:139]
v_perm_b32 v144, v26, v26, v16
v_perm_b32 v145, v26, v26, v17
v_perm_b32 v146, v26, v26, v18
v_perm_b32 v147, v26, v26, v19
v_mfma_f32_16x16x32_bf16 v[132:135], v[96:99], v[140:143], v[132:135]
v_mfma_f32_16x16x32_bf16 v[136:139], v[100:103], v[140:143], v[136:139]
v_perm_b32 v148, v27, v27, v12
v_perm_b32 v149, v27, v27, v13
v_perm_b32 v150, v27, v27, v14
v_perm_b32 v151, v27, v27, v15
v_mfma_f32_16x16x32_bf16 v[132:135], v[104:107], v[144:147], v[132:135]
v_mfma_f32_16x16x32_bf16 v[136:139], v[108:111], v[144:147], v[136:139]
v_perm_b32 v152, v27, v27, v16
v_perm_b32 v153, v27, v27, v17
v_perm_b32 v154, v27, v27, v18
v_perm_b32 v155, v27, v27, v19
v_mfma_f32_16x16x32_bf16 v[132:135], v[112:115], v[148:151], v[132:135]
v_mfma_f32_16x16x32_bf16 v[136:139], v[116:119], v[148:151], v[136:139]
v_mfma_f32_16x16x32_bf16 v[132:135], v[120:123], v[152:155], v[132:135]
v_mfma_f32_16x16x32_bf16 v[136:139], v[124:127], v[152:155], v[136:139]
s_add_u32 s40, s40, 6
s_add_u32 s41, s41, 98304
s_sub_u32 s47, s41, 147456
s_cmp_ge_u32 s41, 147456
s_cselect_b32 s41, s47, s41
s_cmp_lt_u32 s40, s79
s_cbranch_scc1 L_cv
L_cc:
ds_read_b32 v23, v188
s_lshr_b32 s47, s41, 12
v_add_u32 v191, s47, v188
s_add_u32 s42, s40, 1
v_mov_b32 v192, s42
s_waitcnt lgkmcnt(0)
v_readfirstlane_b32 s43, v23
s_and_b32 s46, s43, 0x7fff
s_bfe_u32 s47, s43, 0x1000f
s_add_u32 s46, s46, s47
s_cmp_gt_u32 s46, s40
s_cbranch_scc1 L_cc_go
s_lshr_b32 s46, s43, 16
s_sub_u32 s46, s46, 1
s_cmp_lt_u32 s46, s40
s_cbranch_scc1 L_c_tail
s_sleep 0
s_sub_u32 s45, s45, 1
s_cmp_lg_u32 s45, 0
s_cbranch_scc1 L_cc
s_endpgm
L_cc_go:
v_add_u32 v7, s41, v2
v_add_u32 v8, s41, v3
v_add_u32 v9, s41, v4
v_add_u32 v10, s41, v5
v_add_u32 v11, s41, v6
ds_read_b128 v[64:67], v7 offset:0
ds_read_b128 v[68:71], v8 offset:0
ds_read_b128 v[72:75], v9 offset:0
ds_read_b128 v[76:79], v10 offset:0
ds_read_b128 v[80:83], v7 offset:256
ds_read_b128 v[84:87], v8 offset:256
ds_read_b128 v[88:91], v9 offset:256
ds_read_b128 v[92:95], v10 offset:256
s_waitcnt lgkmcnt(7)
v_mfma_f32_16x16x32_bf16 v[128:131], v[64:67], v[32:35], 0
s_waitcnt lgkmcnt(6)
v_mfma_f32_16x16x32_bf16 v[128:131], v[68:71], v[36:39], v[128:131]
s_waitcnt lgkmcnt(5)
v_mfma_f32_16x16x32_bf16 v[128:131], v[72:75], v[40:43], v[128:131]
s_waitcnt lgkmcnt(4)
v_mfma_f32_16x16x32_bf16 v[128:131], v[76:79], v[44:47], v[128:131]
s_waitcnt lgkmcnt(3)
v_mfma_f32_16x16x32_bf16 v[128:131], v[80:83], v[48:51], v[128:131]
s_waitcnt lgkmcnt(2)
v_mfma_f32_16x16x32_bf16 v[128:131], v[84:87], v[52:55], v[128:131]
s_waitcnt lgkmcnt(1)
v_mfma_f32_16x16x32_bf16 v[128:131], v[88:91], v[56:59], v[128:131]
s_waitcnt lgkmcnt(0)
v_mfma_f32_16x16x32_bf16 v[128:131], v[92:95], v[60:63], v[128:131]
s_nop 7
v_cvt_pk_bf16_f32 v24, v128, v129
v_cvt_pk_bf16_f32 v25, v130, v131
v_lshlrev_b32 v26, 16, v24
v_and_b32 v27, 0xffff0000, v24
v_lshlrev_b32 v28, 16, v25
v_and_b32 v29, 0xffff0000, v25
v_max3_f32 v30, v26, v27, v28
v_max_f32 v30, v30, v29
v_cmp_gt_f32 vcc, v30, v20
s_cbranch_vccnz L_cc_resc
L_cc_resc_ret:
v_fma_f32 v26, v26, s54, -v21
v_fma_f32 v27, v27, s54, -v21
v_fma_f32 v28, v28, s54, -v21
v_fma_f32 v29, v29, s54, -v21
v_exp_f32 v26, v26
v_exp_f32 v27, v27
v_exp_f32 v28, v28
v_exp_f32 v29, v29
s_nop 0
v_cvt_pk_bf16_f32 v24, v26, v27
v_cvt_pk_bf16_f32 v25, v28, v29
v_add_f32 v30, v26, v27
v_add_f32 v31, v28, v29
v_add_f32 v22, v22, v30
v_add_f32 v22, v22, v31
L_cc_w2:
s_and_b32 s46, s43, 0x7fff
s_cmp_gt_u32 s46, s40
s_cbranch_scc1 L_cc_w2go
ds_read_b32 v23, v188
s_waitcnt lgkmcnt(0)
v_readfirstlane_b32 s43, v23
s_sleep 0
s_sub_u32 s45, s45, 1
s_cmp_lg_u32 s45, 0
s_cbranch_scc1 L_cc_w2
s_endpgm
L_cc_w2go:
ds_read_b128 v[96:99], v11 offset:8192
ds_read_b128 v[100:103], v11 offset:8448
ds_read_b128 v[104:107], v11 offset:8704
ds_read_b128 v[108:111], v11 offset:8960
ds_read_b128 v[112:115], v11 offset:9216
ds_read_b128 v[116:119], v11 offset:9472
ds_read_b128 v[120:123], v11 offset:9728
ds_read_b128 v[124:127], v11 offset:9984
v_perm_b32 v140, v24, v24, v12
v_perm_b32 v141, v24, v24, v13
v_perm_b32 v142, v24, v24, v14
v_perm_b32 v143, v24, v24, v15
v_perm_b32 v144, v24, v24, v16
v_perm_b32 v145, v24, v24, v17
v_perm_b32 v146, v24, v24, v18
v_perm_b32 v147, v24, v24, v19
v_perm_b32 v148, v25, v25, v12
v_perm_b32 v149, v25, v25, v13
v_perm_b32 v150, v25, v25, v14
v_perm_b32 v151, v25, v25, v15
v_perm_b32 v152, v25, v25, v16
v_perm_b32 v153, v25, v25, v17
v_perm_b32 v154, v25, v25, v18
v_perm_b32 v155, v25, v25, v19
s_add_u32 s40, s40, 6
s_add_u32 s41, s41, 98304
s_sub_u32 s47, s41, 147456
s_cmp_ge_u32 s41, 147456
s_cselect_b32 s41, s47, s41
s_waitcnt lgkmcnt(7)
v_mfma_f32_16x16x32_bf16 v[132:135], v[96:99], v[140:143], v[132:135]
s_waitcnt lgkmcnt(6)
v_mfma_f32_16x16x32_bf16 v[136:139], v[100:103], v[140:143], v[136:139]
s_waitcnt lgkmcnt(5)
v_mfma_f32_16x16x32_bf16 v[132:135], v[104:107], v[144:147], v[132:135]
s_waitcnt lgkmcnt(4)
v_mfma_f32_16x16x32_bf16 v[136:139], v[108:111], v[144:147], v[136:139]
s_waitcnt lgkmcnt(3)
v_mfma_f32_16x16x32_bf16 v[132:135], v[112:115], v[148:151], v[132:135]
s_waitcnt lgkmcnt(2)
v_mfma_f32_16x16x32_bf16 v[136:139], v[116:119], v[148:151], v[136:139]
s_waitcnt lgkmcnt(1)
v_mfma_f32_16x16x32_bf16 v[132:135], v[120:123], v[152:155], v[132:135]
s_waitcnt lgkmcnt(0)
v_mfma_f32_16x16x32_bf16 v[136:139], v[124:127], v[152:155], v[136:139]
ds_write_b32 v191, v192 offset:64
s_lshr_b32 s46, s43, 16
s_sub_u32 s46, s46, 1
s_cmp_ge_u32 s46, s40
s_cbranch_scc1 L_cc
L_c_tail:
s_add_u32 s47, s41, 49152
s_sub_u32 s48, s47, 147456
s_cmp_ge_u32 s47, 147456
s_cselect_b32 s47, s48, s47
v_lshl_add_u32 v25, v1, 4, s47
v_lshl_add_u32 v26, v1, 3, s47
v_mov_b32 v28, v21
v_mov_b32 v29, v22
ds_write_b64 v26, v[28:29] offset:2048
ds_write_b128 v25, v[132:135]
ds_write_b128 v25, v[136:139] offset:1024
s_cmp_lt_u32 s55, 4
s_cbranch_scc1 L_p_wave
s_sub_u32 s56, s55, 4
s_lshr_b32 s46, s43, 16
s_sub_u32 s46, s40, s46
s_lshl_b32 s46, s46, 14
s_sub_i32 s46, s41, s46
s_sub_i32 s46, s46, 16384
s_add_i32 s47, s46, 147456
s_cmp_lt_i32 s46, 0
s_cselect_b32 s46, s47, s46
v_lshl_add_u32 v70, v1, 3, s46
s_sub_i32 s46, s46, 16384
s_add_i32 s47, s46, 147456
s_cmp_lt_i32 s46, 0
s_cselect_b32 s46, s47, s46
v_lshl_add_u32 v71, v1, 3, s46
s_sub_i32 s46, s46, 16384
s_add_i32 s47, s46, 147456
s_cmp_lt_i32 s46, 0
s_cselect_b32 s46, s47, s46
v_lshl_add_u32 v72, v1, 3, s46
s_sub_i32 s46, s46, 16384
s_add_i32 s47, s46, 147456
s_cmp_lt_i32 s46, 0
s_cselect_b32 s46, s47, s46
v_lshl_add_u32 v73, v1, 3, s46
s_sub_i32 s46, s46, 16384
s_add_i32 s47, s46, 147456
s_cmp_lt_i32 s46, 0
s_cselect_b32 s46, s47, s46
v_lshl_add_u32 v74, v1, 3, s46
s_sub_i32 s46, s46, 16384
s_add_i32 s47, s46, 147456
s_cmp_lt_i32 s46, 0
s_cselect_b32 s46, s47, s46
v_lshl_add_u32 v75, v1, 3, s46
s_lshl_b32 s47, s56, 10
v_lshl_add_u32 v27, v1, 3, s47
v_add_u32 v76, v70, v27
v_add_u32 v77, v71, v27
v_add_u32 v78, v72, v27
v_add_u32 v79, v73, v27
v_add_u32 v80, v74, v27
v_add_u32 v81, v75, v27
v_lshrrev_b32 v26, 3, v189
v_lshlrev_b32 v26, 14, v26
v_lshl_add_u32 v26, v190, 11, v26
v_and_b32 v27, 7, v189
v_lshl_add_u32 v26, v27, 4, v26
s_lshl_b32 s46, s50, 15
s_lshl_b32 s47, s56, 13
s_add_u32 s46, s46, s47
s_lshl_b32 s47, s51, 7
s_add_u32 s46, s46, s47
s_add_u32 s46, s46, 262144
s_waitcnt lgkmcnt(0)
s_barrier
ds_read_b64 v[84:85], v70 offset:2048
ds_read_b64 v[86:87], v71 offset:2048
ds_read_b64 v[88:89], v72 offset:2048
ds_read_b64 v[90:91], v73 offset:2048
ds_read_b64 v[92:93], v74 offset:2048
ds_read_b64 v[94:95], v75 offset:2048
ds_read_b128 v[96:99], v76
ds_read_b128 v[100:103], v77
ds_read_b128 v[104:107], v78
ds_read_b128 v[108:111], v79
ds_read_b128 v[112:115], v80
ds_read_b128 v[116:119], v81
s_waitcnt lgkmcnt(6)
v_max3_f32 v28, v84, v86, v88
v_max3_f32 v28, v28, v90, v92
v_max_f32 v28, v28, v94
v_sub_f32 v84, v84, v28
v_sub_f32 v86, v86, v28
v_sub_f32 v88, v88, v28
v_sub_f32 v90, v90, v28
v_sub_f32 v92, v92, v28
v_sub_f32 v94, v94, v28
v_exp_f32 v84, v84
v_exp_f32 v86, v86
v_exp_f32 v88, v88
v_exp_f32 v90, v90
v_exp_f32 v92, v92
v_exp_f32 v94, v94
s_waitcnt lgkmcnt(0)
v_mul_f32 v120, v84, v96
v_mul_f32 v121, v84, v97
v_mul_f32 v122, v84, v98
v_mul_f32 v123, v84, v99
v_fmac_f32 v120, v86, v100
v_fmac_f32 v121, v86, v101
v_fmac_f32 v122, v86, v102
v_fmac_f32 v123, v86, v103
v_fmac_f32 v120, v88, v104
v_fmac_f32 v121, v88, v105
v_fmac_f32 v122, v88, v106
v_fmac_f32 v123, v88, v107
v_fmac_f32 v120, v90, v108
v_fmac_f32 v121, v90, v109
v_fmac_f32 v122, v90, v110
v_fmac_f32 v123, v90, v111
v_fmac_f32 v120, v92, v112
v_fmac_f32 v121, v92, v113
v_fmac_f32 v122, v92, v114
v_fmac_f32 v123, v92, v115
v_fmac_f32 v120, v94, v116
v_fmac_f32 v121, v94, v117
v_fmac_f32 v122, v94, v118
v_fmac_f32 v123, v94, v119
v_bfi_b32 v120, s59, v212, v120
v_bfi_b32 v121, s59, v213, v121
v_bfi_b32 v122, s59, v214, v122
v_bfi_b32 v123, s59, v215, v123
buffer_store_dwordx4 v[120:123], v26, s[36:39], s46 offen sc1
s_cmp_eq_u32 s56, 0
s_cbranch_scc1 L_x0
v_mul_f32 v29, v84, v85
v_fmac_f32 v29, v86, v87
v_fmac_f32 v29, v88, v89
v_fmac_f32 v29, v90, v91
v_fmac_f32 v29, v92, v93
v_fmac_f32 v29, v94, v95
v_lshlrev_b32 v27, 8, v189
v_mov_b32 v24, v29
s_lshl_b32 s48, s50, 12
s_lshl_b32 s47, s51, 7
v_permlane16_swap_b32 v29, v24
v_add_f32 v29, v29, v24
v_mov_b32 v24, v29
s_add_u32 s48, s48, s47
s_add_u32 s48, s48, 786432
v_permlane32_swap_b32 v29, v24
v_add_f32 v29, v29, v24
v_mov_b32 v30, s58
v_mov_b32 v31, s58
s_mov_b64 exec, 0x101
buffer_store_dwordx4 v[28:31], v27, s[36:39], s48 offen sc1
s_mov_b64 exec, -1
s_barrier
s_endpgm
L_x0:
s_barrier
v_lshlrev_b32 v24, 7, v189
v_lshl_add_u32 v23, v190, 4, v24
s_lshl_b32 s46, s2, 11
s_add_u32 s46, s46, 262144
s_lshl_b32 s48, s50, 12
s_lshr_b32 s47, s51, 3
s_lshl_b32 s47, s47, 11
s_add_u32 s48, s48, s47
s_add_u32 s48, s48, 786432
v_lshl_add_u32 v27, v190, 4, v188
s_waitcnt vmcnt(0)
L_p_poll:
buffer_load_dwordx4 v[64:67], v23, s[36:39], s46 offen sc1
buffer_load_dwordx4 v[68:71], v23, s[36:39], s46 offen offset:64 sc1
buffer_load_dwordx4 v[72:75], v24, s[36:39], s48 offen sc1
s_waitcnt vmcnt(0)
v_xor_b32 v64, v64, v212
v_xor_b32 v65, v65, v213
v_xor_b32 v66, v66, v214
v_xor_b32 v67, v67, v215
v_xor_b32 v68, v68, v212
v_xor_b32 v69, v69, v213
v_xor_b32 v70, v70, v214
v_xor_b32 v71, v71, v215
v_or_b32 v25, v64, v65
v_or3_b32 v25, v25, v66, v67
v_or3_b32 v25, v25, v68, v69
v_or3_b32 v25, v25, v70, v71
v_and_b32 v25, s59, v25
v_bitop3_b32 v25, v25, v74, s58 bitop3:0xf6
v_bitop3_b32 v25, v25, v75, s58 bitop3:0xf6
v_cmp_ne_u32 vcc, 0, v25
s_cbranch_vccz L_p_go
s_or_b32 s76, vcc_lo, vcc_hi
s_lshr_b32 s77, s76, 16
s_or_b32 s76, s76, s77
s_pack_ll_b32_b16 s76, s76, s76
s_mov_b32 exec_lo, s76
s_mov_b32 exec_hi, s76
s_sleep 1
s_sub_u32 s45, s45, 1
s_cmp_lg_u32 s45, 0
s_cbranch_scc1 L_p_poll
s_endpgm
L_p_go:
s_mov_b64 exec, -1
v_mov_b32 v26, v72
s_nop 1
v_max_f32_dpp v26, v26, v26 row_ror:8 row_mask:0xf bank_mask:0xf
s_nop 1
v_max_f32_dpp v26, v26, v26 row_ror:4 row_mask:0xf bank_mask:0xf
s_nop 1
v_max_f32_dpp v26, v26, v26 row_ror:2 row_mask:0xf bank_mask:0xf
s_nop 1
v_max_f32_dpp v26, v26, v26 row_ror:1 row_mask:0xf bank_mask:0xf
v_sub_f32 v26, v72, v26
v_exp_f32 v26, v26
s_nop 0
v_mul_f32 v88, v73, v26
v_mul_f32 v80, v64, v26
v_mul_f32 v81, v65, v26
v_mul_f32 v82, v66, v26
v_mul_f32 v83, v67, v26
v_mul_f32 v84, v68, v26
v_mul_f32 v85, v69, v26
v_mul_f32 v86, v70, v26
v_mul_f32 v87, v71, v26
v_add_f32_dpp v88, v88, v88 row_ror:8 row_mask:0xf bank_mask:0xf
v_add_f32_dpp v80, v80, v80 row_ror:8 row_mask:0xf bank_mask:0xf
v_add_f32_dpp v81, v81, v81 row_ror:8 row_mask:0xf bank_mask:0xf
v_add_f32_dpp v82, v82, v82 row_ror:8 row_mask:0xf bank_mask:0xf
v_add_f32_dpp v83, v83, v83 row_ror:8 row_mask:0xf bank_mask:0xf
v_add_f32_dpp v84, v84, v84 row_ror:8 row_mask:0xf bank_mask:0xf
v_add_f32_dpp v85, v85, v85 row_ror:8 row_mask:0xf bank_mask:0xf
v_add_f32_dpp v86, v86, v86 row_ror:8 row_mask:0xf bank_mask:0xf
v_add_f32_dpp v87, v87, v87 row_ror:8 row_mask:0xf bank_mask:0xf
v_add_f32_dpp v88, v88, v88 row_ror:4 row_mask:0xf bank_mask:0xf
v_add_f32_dpp v80, v80, v80 row_ror:4 row_mask:0xf bank_mask:0xf
v_add_f32_dpp v81, v81, v81 row_ror:4 row_mask:0xf bank_mask:0xf
v_add_f32_dpp v82, v82, v82 row_ror:4 row_mask:0xf bank_mask:0xf
v_add_f32_dpp v83, v83, v83 row_ror:4 row_mask:0xf bank_mask:0xf
v_add_f32_dpp v84, v84, v84 row_ror:4 row_mask:0xf bank_mask:0xf
v_add_f32_dpp v85, v85, v85 row_ror:4 row_mask:0xf bank_mask:0xf
v_add_f32_dpp v86, v86, v86 row_ror:4 row_mask:0xf bank_mask:0xf
v_add_f32_dpp v87, v87, v87 row_ror:4 row_mask:0xf bank_mask:0xf
v_add_f32_dpp v88, v88, v88 row_ror:2 row_mask:0xf bank_mask:0xf
v_add_f32_dpp v80, v80, v80 row_ror:2 row_mask:0xf bank_mask:0xf
v_add_f32_dpp v81, v81, v81 row_ror:2 row_mask:0xf bank_mask:0xf
v_add_f32_dpp v82, v82, v82 row_ror:2 row_mask:0xf bank_mask:0xf
v_add_f32_dpp v83, v83, v83 row_ror:2 row_mask:0xf bank_mask:0xf
v_add_f32_dpp v84, v84, v84 row_ror:2 row_mask:0xf bank_mask:0xf
v_add_f32_dpp v85, v85, v85 row_ror:2 row_mask:0xf bank_mask:0xf
v_add_f32_dpp v86, v86, v86 row_ror:2 row_mask:0xf bank_mask:0xf
v_add_f32_dpp v87, v87, v87 row_ror:2 row_mask:0xf bank_mask:0xf
v_add_f32_dpp v88, v88, v88 row_ror:1 row_mask:0xf bank_mask:0xf
v_add_f32_dpp v80, v80, v80 row_ror:1 row_mask:0xf bank_mask:0xf
v_add_f32_dpp v81, v81, v81 row_ror:1 row_mask:0xf bank_mask:0xf
v_add_f32_dpp v82, v82, v82 row_ror:1 row_mask:0xf bank_mask:0xf
v_rcp_f32 v88, v88
v_add_f32_dpp v83, v83, v83 row_ror:1 row_mask:0xf bank_mask:0xf
v_add_f32_dpp v84, v84, v84 row_ror:1 row_mask:0xf bank_mask:0xf
v_add_f32_dpp v85, v85, v85 row_ror:1 row_mask:0xf bank_mask:0xf
v_add_f32_dpp v86, v86, v86 row_ror:1 row_mask:0xf bank_mask:0xf
v_add_f32_dpp v87, v87, v87 row_ror:1 row_mask:0xf bank_mask:0xf
v_mul_f32 v80, v80, v88
v_mul_f32 v81, v81, v88
v_mul_f32 v82, v82, v88
v_mul_f32 v83, v83, v88
v_mul_f32 v84, v84, v88
v_mul_f32 v85, v85, v88
v_mul_f32 v86, v86, v88
v_mul_f32 v87, v87, v88
v_cvt_pk_bf16_f32 v76, v80, v81
v_cvt_pk_bf16_f32 v77, v82, v83
v_cvt_pk_bf16_f32 v78, v84, v85
v_cvt_pk_bf16_f32 v79, v86, v87
s_mov_b32 exec_lo, 0x00010001
s_mov_b32 exec_hi, 0x00010001
ds_write_b128 v27, v[76:79] offset:160
s_waitcnt lgkmcnt(0)
s_barrier
s_endpgm
L_p_wave:
v_lshl_add_u32 v27, v190, 4, v188
v_lshlrev_b32 v23, 14, v190
v_lshl_add_u32 v23, v189, 4, v23
s_lshl_b32 s46, s52, 18
s_lshl_b32 s47, s55, 16
s_add_u32 s46, s46, s47
s_and_b32 s47, s2, 127
s_lshl_b32 s47, s47, 7
s_add_u32 s46, s46, s47
s_add_u32 s46, s46, 851968
s_cmp_eq_u32 s55, 3
s_cselect_b32 s47, 0, 0x00ff00ff
s_waitcnt lgkmcnt(0)
s_barrier
s_barrier
buffer_load_dwordx4 v[156:159], v204, s[28:31], s82 offen offset:0
buffer_load_dwordx4 v[172:175], v204, s[28:31], s82 offen offset:3584
s_add_u32 s82, s82, 7168
buffer_load_dwordx4 v[160:163], v204, s[28:31], s82 offen offset:0
buffer_load_dwordx4 v[176:179], v204, s[28:31], s82 offen offset:3584
s_add_u32 s82, s82, 7168
buffer_load_dwordx4 v[164:167], v204, s[28:31], s82 offen offset:0
buffer_load_dwordx4 v[180:183], v204, s[28:31], s82 offen offset:3584
s_add_u32 s82, s82, 7168
buffer_load_dwordx4 v[168:171], v204, s[28:31], s82 offen offset:0
buffer_load_dwordx4 v[184:187], v204, s[28:31], s82 offen offset:3584
s_waitcnt vmcnt(0)
s_barrier
ds_read_b128 v[76:79], v27 offset:160
s_waitcnt lgkmcnt(0)
v_perm_b32 v96, v76, v76, v12
v_perm_b32 v97, v76, v76, v13
v_perm_b32 v98, v76, v76, v14
v_perm_b32 v99, v76, v76, v15
v_perm_b32 v100, v76, v76, v16
v_perm_b32 v101, v76, v76, v17
v_perm_b32 v102, v76, v76, v18
v_perm_b32 v103, v76, v76, v19
v_mfma_f32_16x16x32_bf16 v[128:131], v[156:159], v[96:99], 0
v_perm_b32 v104, v77, v77, v12
v_perm_b32 v105, v77, v77, v13
v_perm_b32 v106, v77, v77, v14
v_perm_b32 v107, v77, v77, v15
v_mfma_f32_16x16x32_bf16 v[128:131], v[160:163], v[100:103], v[128:131]
v_perm_b32 v108, v77, v77, v16
v_perm_b32 v109, v77, v77, v17
v_perm_b32 v110, v77, v77, v18
v_perm_b32 v111, v77, v77, v19
v_mfma_f32_16x16x32_bf16 v[128:131], v[164:167], v[104:107], v[128:131]
v_perm_b32 v112, v78, v78, v12
v_perm_b32 v113, v78, v78, v13
v_perm_b32 v114, v78, v78, v14
v_perm_b32 v115, v78, v78, v15
v_mfma_f32_16x16x32_bf16 v[128:131], v[168:171], v[108:111], v[128:131]
v_perm_b32 v116, v78, v78, v16
v_perm_b32 v117, v78, v78, v17
v_perm_b32 v118, v78, v78, v18
v_perm_b32 v119, v78, v78, v19
v_mfma_f32_16x16x32_bf16 v[128:131], v[172:175], v[112:115], v[128:131]
v_perm_b32 v120, v79, v79, v12
v_perm_b32 v121, v79, v79, v13
v_perm_b32 v122, v79, v79, v14
v_perm_b32 v123, v79, v79, v15
v_mfma_f32_16x16x32_bf16 v[128:131], v[176:179], v[116:119], v[128:131]
v_perm_b32 v124, v79, v79, v16
v_perm_b32 v125, v79, v79, v17
v_perm_b32 v126, v79, v79, v18
v_perm_b32 v127, v79, v79, v19
v_mfma_f32_16x16x32_bf16 v[128:131], v[180:183], v[120:123], v[128:131]
s_nop 0
v_mfma_f32_16x16x32_bf16 v[128:131], v[184:187], v[124:127], v[128:131]
s_mov_b32 exec_lo, 0x00ff00ff
s_mov_b32 exec_hi, s47
s_nop 5
v_bfi_b32 v128, s59, v212, v128
v_bfi_b32 v129, s59, v213, v129
v_bfi_b32 v130, s59, v214, v130
v_bfi_b32 v131, s59, v215, v131
buffer_store_dwordx4 v[128:131], v23, s[36:39], s46 offen sc1
s_mov_b64 exec, -1
s_waitcnt vmcnt(0)
s_endpgm
L_cv_resc:
v_mov_b32 v31, v30
s_nop 1
v_permlane16_swap_b32 v30, v31
v_max_f32 v30, v30, v31
v_mov_b32 v31, v30
s_nop 1
v_permlane32_swap_b32 v30, v31
v_max3_f32 v20, v30, v31, v20
v_mul_f32 v30, s54, v20
v_sub_f32 v31, v21, v30
v_exp_f32 v31, v31
v_mov_b32 v21, v30
v_mul_f32 v132, v132, v31
v_mul_f32 v133, v133, v31
v_mul_f32 v134, v134, v31
v_mul_f32 v135, v135, v31
v_mul_f32 v136, v136, v31
v_mul_f32 v137, v137, v31
v_mul_f32 v138, v138, v31
v_mul_f32 v139, v139, v31
v_mul_f32 v22, v22, v31
s_branch L_cv_resc_ret
L_cc_resc:
v_mov_b32 v31, v30
s_nop 1
v_permlane16_swap_b32 v30, v31
v_max_f32 v30, v30, v31
v_mov_b32 v31, v30
s_nop 1
v_permlane32_swap_b32 v30, v31
v_max3_f32 v20, v30, v31, v20
v_mul_f32 v30, s54, v20
v_sub_f32 v31, v21, v30
v_exp_f32 v31, v31
v_mov_b32 v21, v30
v_mul_f32 v132, v132, v31
v_mul_f32 v133, v133, v31
v_mul_f32 v134, v134, v31
v_mul_f32 v135, v135, v31
v_mul_f32 v136, v136, v31
v_mul_f32 v137, v137, v31
v_mul_f32 v138, v138, v31
v_mul_f32 v139, v139, v31
v_mul_f32 v22, v22, v31
s_branch L_cc_resc_ret
L_c_first:
L_c_qwait:
ds_read_b32 v23, v188 offset:4
s_waitcnt lgkmcnt(0)
v_readfirstlane_b32 s46, v23
s_cmp_lg_u32 s46, 0
s_cbranch_scc1 L_c_qgo
s_sleep 1
s_sub_u32 s45, s45, 1
s_cmp_lg_u32 s45, 0
s_cbranch_scc1 L_c_qwait
s_endpgm
L_c_qgo:
v_lshrrev_b32 v23, 3, v189
v_lshlrev_b32 v23, 9, v23
v_lshl_add_u32 v23, v190, 4, v23
v_add_u32 v23, 147712, v23
ds_read_b128 v[32:35], v23 offset:0
ds_read_b128 v[36:39], v23 offset:64
ds_read_b128 v[40:43], v23 offset:128
ds_read_b128 v[44:47], v23 offset:192
ds_read_b128 v[48:51], v23 offset:256
ds_read_b128 v[52:55], v23 offset:320
ds_read_b128 v[56:59], v23 offset:384
ds_read_b128 v[60:63], v23 offset:448
s_mov_b32 s44, 1
s_waitcnt lgkmcnt(0)
s_branch L_ck_comp
L_helper:
s_mov_b32 s28, s4
s_and_b32 s29, s5, 0xffff
s_mov_b32 s30, 1792
s_mov_b32 s31, 0x20000
s_mov_b32 s32, s10
s_and_b32 s33, s11, 0xffff
s_mov_b32 s34, 3670016
s_mov_b32 s35, 0x20000
v_lshrrev_b32 v20, 5, v1
v_and_b32 v21, 31, v1
v_mul_u32_u24 v22, 896, v20
v_lshl_add_u32 v22, v21, 2, v22
buffer_load_dword v24, v22, s[28:31], 0 offen offset:0
buffer_load_dword v25, v22, s[28:31], 0 offen offset:128
buffer_load_dword v26, v22, s[28:31], 0 offen offset:256
buffer_load_dword v27, v22, s[28:31], 0 offen offset:384
buffer_load_dword v28, v22, s[28:31], 0 offen offset:512
buffer_load_dword v29, v22, s[28:31], 0 offen offset:640
buffer_load_dword v30, v22, s[28:31], 0 offen offset:768
s_and_b32 s56, s51, 7
s_lshl_b32 s56, s56, 1
s_lshr_b32 s57, s51, 3
s_add_u32 s56, s56, s57
v_lshrrev_b32 v23, 2, v1
v_mul_u32_u24 v23, 229376, v23
v_and_b32 v31, 3, v1
v_lshl_add_u32 v23, v31, 4, v23
s_lshl_b32 s46, s53, 10
s_lshl_b32 s47, s56, 6
s_add_u32 s46, s46, s47
buffer_load_dwordx4 v[64:67], v23, s[32:35], s46 offen nt
s_add_u32 s46, s46, 8192
buffer_load_dwordx4 v[68:71], v23, s[32:35], s46 offen nt
s_add_u32 s46, s46, 8192
buffer_load_dwordx4 v[72:75], v23, s[32:35], s46 offen nt
s_add_u32 s46, s46, 8192
buffer_load_dwordx4 v[76:79], v23, s[32:35], s46 offen nt
s_add_u32 s46, s46, 8192
buffer_load_dwordx4 v[80:83], v23, s[32:35], s46 offen nt
s_add_u32 s46, s46, 8192
buffer_load_dwordx4 v[84:87], v23, s[32:35], s46 offen nt
s_add_u32 s46, s46, 8192
buffer_load_dwordx4 v[88:91], v23, s[32:35], s46 offen nt
s_add_u32 s46, s46, 8192
buffer_load_dwordx4 v[92:95], v23, s[32:35], s46 offen nt
s_add_u32 s46, s46, 8192
buffer_load_dwordx4 v[96:99], v23, s[32:35], s46 offen nt
s_add_u32 s46, s46, 8192
buffer_load_dwordx4 v[100:103], v23, s[32:35], s46 offen nt
s_add_u32 s46, s46, 8192
buffer_load_dwordx4 v[104:107], v23, s[32:35], s46 offen nt
s_add_u32 s46, s46, 8192
buffer_load_dwordx4 v[108:111], v23, s[32:35], s46 offen nt
s_add_u32 s46, s46, 8192
buffer_load_dwordx4 v[112:115], v23, s[32:35], s46 offen nt
s_add_u32 s46, s46, 8192
buffer_load_dwordx4 v[116:119], v23, s[32:35], s46 offen nt
s_add_u32 s46, s46, 8192
buffer_load_dwordx4 v[120:123], v23, s[32:35], s46 offen nt
s_add_u32 s46, s46, 8192
buffer_load_dwordx4 v[124:127], v23, s[32:35], s46 offen nt
s_add_u32 s46, s46, 8192
buffer_load_dwordx4 v[128:131], v23, s[32:35], s46 offen nt
s_add_u32 s46, s46, 8192
buffer_load_dwordx4 v[132:135], v23, s[32:35], s46 offen nt
s_add_u32 s46, s46, 8192
buffer_load_dwordx4 v[136:139], v23, s[32:35], s46 offen nt
s_add_u32 s46, s46, 8192
buffer_load_dwordx4 v[140:143], v23, s[32:35], s46 offen nt
s_add_u32 s46, s46, 8192
buffer_load_dwordx4 v[144:147], v23, s[32:35], s46 offen nt
s_add_u32 s46, s46, 8192
buffer_load_dwordx4 v[148:151], v23, s[32:35], s46 offen nt
s_add_u32 s46, s46, 8192
buffer_load_dwordx4 v[152:155], v23, s[32:35], s46 offen nt
s_add_u32 s46, s46, 8192
buffer_load_dwordx4 v[156:159], v23, s[32:35], s46 offen nt
s_add_u32 s46, s46, 8192
buffer_load_dwordx4 v[160:163], v23, s[32:35], s46 offen nt
s_add_u32 s46, s46, 8192
buffer_load_dwordx4 v[164:167], v23, s[32:35], s46 offen nt
s_add_u32 s46, s46, 8192
buffer_load_dwordx4 v[168:171], v23, s[32:35], s46 offen nt
s_add_u32 s46, s46, 8192
buffer_load_dwordx4 v[172:175], v23, s[32:35], s46 offen nt
s_mul_i32 s46, s50, 4352
s_add_u32 s46, s46, 4096
s_cmp_eq_u32 s51, 0
s_cselect_b32 s46, s46, 4194304
v_mov_b32 v186, 0
s_mov_b64 exec, 1
buffer_store_dword v186, v186, s[36:39], s46 offen sc1
s_mov_b64 exec, -1
s_waitcnt lgkmcnt(0)
s_add_u32 s58, s58, 0x1111
s_bfe_u32 s46, s58, 0x40000
v_mov_b32 v212, s46
s_bfe_u32 s46, s58, 0x40004
v_mov_b32 v213, s46
s_bfe_u32 s46, s58, 0x40008
v_mov_b32 v214, s46
s_bfe_u32 s46, s58, 0x4000c
v_mov_b32 v215, s46
s_waitcnt vmcnt(29)
v_lshlrev_b32 v32, 16, v24
v_and_b32 v33, 0xffff0000, v24
v_lshlrev_b32 v34, 16, v25
v_and_b32 v35, 0xffff0000, v25
v_lshlrev_b32 v36, 16, v26
v_and_b32 v37, 0xffff0000, v26
v_lshlrev_b32 v38, 16, v27
v_and_b32 v39, 0xffff0000, v27
v_lshlrev_b32 v40, 16, v28
v_and_b32 v41, 0xffff0000, v28
v_lshlrev_b32 v42, 16, v29
v_and_b32 v43, 0xffff0000, v29
v_lshlrev_b32 v44, 16, v30
v_and_b32 v45, 0xffff0000, v30
v_add_f32 v46, v32, v33
v_add_f32 v46, v46, v34
v_add_f32 v46, v46, v35
v_add_f32 v46, v46, v36
v_add_f32 v46, v46, v37
v_add_f32 v46, v46, v38
v_add_f32 v46, v46, v39
v_add_f32 v46, v46, v40
v_add_f32 v46, v46, v41
v_add_f32 v46, v46, v42
v_add_f32 v46, v46, v43
v_add_f32 v46, v46, v44
v_add_f32 v46, v46, v45
s_nop 1
v_add_f32_dpp v46, v46, v46 row_ror:8 row_mask:0xf bank_mask:0xf
s_nop 1
v_add_f32_dpp v46, v46, v46 row_ror:4 row_mask:0xf bank_mask:0xf
s_nop 1
v_add_f32_dpp v46, v46, v46 row_ror:2 row_mask:0xf bank_mask:0xf
s_nop 1
v_add_f32_dpp v46, v46, v46 row_ror:1 row_mask:0xf bank_mask:0xf
v_mov_b32 v47, v46
s_nop 1
v_permlane16_swap_b32 v46, v47
v_add_f32 v46, v46, v47
v_mul_f32 v46, 0x3b124925, v46
v_sub_f32 v48, v32, v46
v_mul_f32 v47, v48, v48
v_sub_f32 v48, v33, v46
v_fmac_f32 v47, v48, v48
v_sub_f32 v48, v34, v46
v_fmac_f32 v47, v48, v48
v_sub_f32 v48, v35, v46
v_fmac_f32 v47, v48, v48
v_sub_f32 v48, v36, v46
v_fmac_f32 v47, v48, v48
v_sub_f32 v48, v37, v46
v_fmac_f32 v47, v48, v48
v_sub_f32 v48, v38, v46
v_fmac_f32 v47, v48, v48
v_sub_f32 v48, v39, v46
v_fmac_f32 v47, v48, v48
v_sub_f32 v48, v40, v46
v_fmac_f32 v47, v48, v48
v_sub_f32 v48, v41, v46
v_fmac_f32 v47, v48, v48
v_sub_f32 v48, v42, v46
v_fmac_f32 v47, v48, v48
v_sub_f32 v48, v43, v46
v_fmac_f32 v47, v48, v48
v_sub_f32 v48, v44, v46
v_fmac_f32 v47, v48, v48
v_sub_f32 v48, v45, v46
v_fmac_f32 v47, v48, v48
s_nop 1
v_add_f32_dpp v47, v47, v47 row_ror:8 row_mask:0xf bank_mask:0xf
s_nop 1
v_add_f32_dpp v47, v47, v47 row_ror:4 row_mask:0xf bank_mask:0xf
s_nop 1
v_add_f32_dpp v47, v47, v47 row_ror:2 row_mask:0xf bank_mask:0xf
s_nop 1
v_add_f32_dpp v47, v47, v47 row_ror:1 row_mask:0xf bank_mask:0xf
v_mov_b32 v48, v47
s_nop 1
v_permlane16_swap_b32 v47, v48
v_add_f32 v47, v47, v48
v_mul_f32 v47, 0x3b124925, v47
v_cvt_pk_bf16_f32 v48, v46, v47
v_lshlrev_b32 v46, 16, v48
v_and_b32 v47, 0xffff0000, v48
v_add_f32 v47, 0x3727c5ac, v47
v_cvt_pk_bf16_f32 v47, v47, v47
v_lshlrev_b32 v47, 16, v47
v_sqrt_f32 v47, v47
s_nop 0
v_cvt_pk_bf16_f32 v47, v47, v47
v_lshlrev_b32 v47, 16, v47
v_rcp_f32 v47, v47
v_sub_f32 v32, v32, v46
v_sub_f32 v33, v33, v46
v_sub_f32 v34, v34, v46
v_sub_f32 v35, v35, v46
v_sub_f32 v36, v36, v46
v_sub_f32 v37, v37, v46
v_sub_f32 v38, v38, v46
v_sub_f32 v39, v39, v46
v_sub_f32 v40, v40, v46
v_sub_f32 v41, v41, v46
v_sub_f32 v42, v42, v46
v_sub_f32 v43, v43, v46
v_sub_f32 v44, v44, v46
v_sub_f32 v45, v45, v46
v_cvt_pk_bf16_f32 v24, v32, v33
v_cvt_pk_bf16_f32 v25, v34, v35
v_cvt_pk_bf16_f32 v26, v36, v37
v_cvt_pk_bf16_f32 v27, v38, v39
v_cvt_pk_bf16_f32 v28, v40, v41
v_cvt_pk_bf16_f32 v29, v42, v43
v_cvt_pk_bf16_f32 v30, v44, v45
v_lshlrev_b32 v32, 16, v24
v_and_b32 v33, 0xffff0000, v24
v_lshlrev_b32 v34, 16, v25
v_and_b32 v35, 0xffff0000, v25
v_lshlrev_b32 v36, 16, v26
v_and_b32 v37, 0xffff0000, v26
v_lshlrev_b32 v38, 16, v27
v_and_b32 v39, 0xffff0000, v27
v_lshlrev_b32 v40, 16, v28
v_and_b32 v41, 0xffff0000, v28
v_lshlrev_b32 v42, 16, v29
v_and_b32 v43, 0xffff0000, v29
v_lshlrev_b32 v44, 16, v30
v_and_b32 v45, 0xffff0000, v30
v_mul_f32 v32, v32, v47
v_mul_f32 v33, v33, v47
v_mul_f32 v34, v34, v47
v_mul_f32 v35, v35, v47
v_mul_f32 v36, v36, v47
v_mul_f32 v37, v37, v47
v_mul_f32 v38, v38, v47
v_mul_f32 v39, v39, v47
v_mul_f32 v40, v40, v47
v_mul_f32 v41, v41, v47
v_mul_f32 v42, v42, v47
v_mul_f32 v43, v43, v47
v_mul_f32 v44, v44, v47
v_mul_f32 v45, v45, v47
v_cvt_pk_bf16_f32 v24, v32, v33
v_cvt_pk_bf16_f32 v25, v34, v35
v_cvt_pk_bf16_f32 v26, v36, v37
v_cvt_pk_bf16_f32 v27, v38, v39
v_cvt_pk_bf16_f32 v28, v40, v41
v_cvt_pk_bf16_f32 v29, v42, v43
v_cvt_pk_bf16_f32 v30, v44, v45
v_add_u32 v22, 148736, v22
ds_write_b32 v22, v24 offset:0
ds_write_b32 v22, v25 offset:128
ds_write_b32 v22, v26 offset:256
ds_write_b32 v22, v27 offset:384
ds_write_b32 v22, v28 offset:512
ds_write_b32 v22, v29 offset:640
ds_write_b32 v22, v30 offset:768
s_mul_i32 s46, s52, 896
s_add_u32 s46, s46, 148736
v_lshrrev_b32 v22, 3, v10
v_lshl_add_u32 v22, v11, 2, v22
v_mul_u32_u24 v22, 56, v22
v_add_u32 v22, s46, v22
s_waitcnt lgkmcnt(0)
ds_read_b64 v[32:33], v22 offset:0
ds_read_b64 v[34:35], v22 offset:8
ds_read_b64 v[36:37], v22 offset:16
ds_read_b64 v[38:39], v22 offset:24
ds_read_b64 v[40:41], v22 offset:32
ds_read_b64 v[42:43], v22 offset:40
ds_read_b64 v[44:45], v22 offset:48
ds_read_b64 v[176:177], v22 offset:112
ds_read_b64 v[178:179], v22 offset:120
ds_read_b64 v[180:181], v22 offset:128
ds_read_b64 v[182:183], v22 offset:136
ds_read_b64 v[184:185], v22 offset:144
ds_read_b64 v[186:187], v22 offset:152
ds_read_b64 v[188:189], v22 offset:160
s_waitcnt lgkmcnt(0)
v_perm_b32 v48, v32, v32, v12
v_perm_b32 v49, v32, v32, v13
v_perm_b32 v50, v32, v32, v14
v_perm_b32 v51, v32, v32, v15
v_perm_b32 v52, v176, v176, v12
v_perm_b32 v53, v176, v176, v13
v_perm_b32 v54, v176, v176, v14
v_perm_b32 v55, v176, v176, v15
s_waitcnt vmcnt(28)
v_mfma_f32_16x16x32_bf16 v[56:59], v[64:67], v[48:51], 0
v_mfma_f32_16x16x32_bf16 v[60:63], v[64:67], v[52:55], 0
v_perm_b32 v48, v32, v32, v16
v_perm_b32 v49, v32, v32, v17
v_perm_b32 v50, v32, v32, v18
v_perm_b32 v51, v32, v32, v19
v_perm_b32 v52, v176, v176, v16
v_perm_b32 v53, v176, v176, v17
v_perm_b32 v54, v176, v176, v18
v_perm_b32 v55, v176, v176, v19
s_waitcnt vmcnt(27)
v_mfma_f32_16x16x32_bf16 v[56:59], v[68:71], v[48:51], v[56:59]
v_mfma_f32_16x16x32_bf16 v[60:63], v[68:71], v[52:55], v[60:63]
v_perm_b32 v48, v33, v33, v12
v_perm_b32 v49, v33, v33, v13
v_perm_b32 v50, v33, v33, v14
v_perm_b32 v51, v33, v33, v15
v_perm_b32 v52, v177, v177, v12
v_perm_b32 v53, v177, v177, v13
v_perm_b32 v54, v177, v177, v14
v_perm_b32 v55, v177, v177, v15
s_waitcnt vmcnt(26)
v_mfma_f32_16x16x32_bf16 v[56:59], v[72:75], v[48:51], v[56:59]
v_mfma_f32_16x16x32_bf16 v[60:63], v[72:75], v[52:55], v[60:63]
v_perm_b32 v48, v33, v33, v16
v_perm_b32 v49, v33, v33, v17
v_perm_b32 v50, v33, v33, v18
v_perm_b32 v51, v33, v33, v19
v_perm_b32 v52, v177, v177, v16
v_perm_b32 v53, v177, v177, v17
v_perm_b32 v54, v177, v177, v18
v_perm_b32 v55, v177, v177, v19
s_waitcnt vmcnt(25)
v_mfma_f32_16x16x32_bf16 v[56:59], v[76:79], v[48:51], v[56:59]
v_mfma_f32_16x16x32_bf16 v[60:63], v[76:79], v[52:55], v[60:63]
v_perm_b32 v48, v34, v34, v12
v_perm_b32 v49, v34, v34, v13
v_perm_b32 v50, v34, v34, v14
v_perm_b32 v51, v34, v34, v15
v_perm_b32 v52, v178, v178, v12
v_perm_b32 v53, v178, v178, v13
v_perm_b32 v54, v178, v178, v14
v_perm_b32 v55, v178, v178, v15
s_waitcnt vmcnt(24)
v_mfma_f32_16x16x32_bf16 v[56:59], v[80:83], v[48:51], v[56:59]
v_mfma_f32_16x16x32_bf16 v[60:63], v[80:83], v[52:55], v[60:63]
v_perm_b32 v48, v34, v34, v16
v_perm_b32 v49, v34, v34, v17
v_perm_b32 v50, v34, v34, v18
v_perm_b32 v51, v34, v34, v19
v_perm_b32 v52, v178, v178, v16
v_perm_b32 v53, v178, v178, v17
v_perm_b32 v54, v178, v178, v18
v_perm_b32 v55, v178, v178, v19
s_waitcnt vmcnt(23)
v_mfma_f32_16x16x32_bf16 v[56:59], v[84:87], v[48:51], v[56:59]
v_mfma_f32_16x16x32_bf16 v[60:63], v[84:87], v[52:55], v[60:63]
v_perm_b32 v48, v35, v35, v12
v_perm_b32 v49, v35, v35, v13
v_perm_b32 v50, v35, v35, v14
v_perm_b32 v51, v35, v35, v15
v_perm_b32 v52, v179, v179, v12
v_perm_b32 v53, v179, v179, v13
v_perm_b32 v54, v179, v179, v14
v_perm_b32 v55, v179, v179, v15
s_waitcnt vmcnt(22)
v_mfma_f32_16x16x32_bf16 v[56:59], v[88:91], v[48:51], v[56:59]
v_mfma_f32_16x16x32_bf16 v[60:63], v[88:91], v[52:55], v[60:63]
v_perm_b32 v48, v35, v35, v16
v_perm_b32 v49, v35, v35, v17
v_perm_b32 v50, v35, v35, v18
v_perm_b32 v51, v35, v35, v19
v_perm_b32 v52, v179, v179, v16
v_perm_b32 v53, v179, v179, v17
v_perm_b32 v54, v179, v179, v18
v_perm_b32 v55, v179, v179, v19
s_waitcnt vmcnt(21)
v_mfma_f32_16x16x32_bf16 v[56:59], v[92:95], v[48:51], v[56:59]
v_mfma_f32_16x16x32_bf16 v[60:63], v[92:95], v[52:55], v[60:63]
v_perm_b32 v48, v36, v36, v12
v_perm_b32 v49, v36, v36, v13
v_perm_b32 v50, v36, v36, v14
v_perm_b32 v51, v36, v36, v15
v_perm_b32 v52, v180, v180, v12
v_perm_b32 v53, v180, v180, v13
v_perm_b32 v54, v180, v180, v14
v_perm_b32 v55, v180, v180, v15
s_waitcnt vmcnt(20)
v_mfma_f32_16x16x32_bf16 v[56:59], v[96:99], v[48:51], v[56:59]
v_mfma_f32_16x16x32_bf16 v[60:63], v[96:99], v[52:55], v[60:63]
v_perm_b32 v48, v36, v36, v16
v_perm_b32 v49, v36, v36, v17
v_perm_b32 v50, v36, v36, v18
v_perm_b32 v51, v36, v36, v19
v_perm_b32 v52, v180, v180, v16
v_perm_b32 v53, v180, v180, v17
v_perm_b32 v54, v180, v180, v18
v_perm_b32 v55, v180, v180, v19
s_waitcnt vmcnt(19)
v_mfma_f32_16x16x32_bf16 v[56:59], v[100:103], v[48:51], v[56:59]
v_mfma_f32_16x16x32_bf16 v[60:63], v[100:103], v[52:55], v[60:63]
v_perm_b32 v48, v37, v37, v12
v_perm_b32 v49, v37, v37, v13
v_perm_b32 v50, v37, v37, v14
v_perm_b32 v51, v37, v37, v15
v_perm_b32 v52, v181, v181, v12
v_perm_b32 v53, v181, v181, v13
v_perm_b32 v54, v181, v181, v14
v_perm_b32 v55, v181, v181, v15
s_waitcnt vmcnt(18)
v_mfma_f32_16x16x32_bf16 v[56:59], v[104:107], v[48:51], v[56:59]
v_mfma_f32_16x16x32_bf16 v[60:63], v[104:107], v[52:55], v[60:63]
v_perm_b32 v48, v37, v37, v16
v_perm_b32 v49, v37, v37, v17
v_perm_b32 v50, v37, v37, v18
v_perm_b32 v51, v37, v37, v19
v_perm_b32 v52, v181, v181, v16
v_perm_b32 v53, v181, v181, v17
v_perm_b32 v54, v181, v181, v18
v_perm_b32 v55, v181, v181, v19
s_waitcnt vmcnt(17)
v_mfma_f32_16x16x32_bf16 v[56:59], v[108:111], v[48:51], v[56:59]
v_mfma_f32_16x16x32_bf16 v[60:63], v[108:111], v[52:55], v[60:63]
v_perm_b32 v48, v38, v38, v12
v_perm_b32 v49, v38, v38, v13
v_perm_b32 v50, v38, v38, v14
v_perm_b32 v51, v38, v38, v15
v_perm_b32 v52, v182, v182, v12
v_perm_b32 v53, v182, v182, v13
v_perm_b32 v54, v182, v182, v14
v_perm_b32 v55, v182, v182, v15
s_waitcnt vmcnt(16)
v_mfma_f32_16x16x32_bf16 v[56:59], v[112:115], v[48:51], v[56:59]
v_mfma_f32_16x16x32_bf16 v[60:63], v[112:115], v[52:55], v[60:63]
v_perm_b32 v48, v38, v38, v16
v_perm_b32 v49, v38, v38, v17
v_perm_b32 v50, v38, v38, v18
v_perm_b32 v51, v38, v38, v19
v_perm_b32 v52, v182, v182, v16
v_perm_b32 v53, v182, v182, v17
v_perm_b32 v54, v182, v182, v18
v_perm_b32 v55, v182, v182, v19
s_waitcnt vmcnt(15)
v_mfma_f32_16x16x32_bf16 v[56:59], v[116:119], v[48:51], v[56:59]
v_mfma_f32_16x16x32_bf16 v[60:63], v[116:119], v[52:55], v[60:63]
v_perm_b32 v48, v39, v39, v12
v_perm_b32 v49, v39, v39, v13
v_perm_b32 v50, v39, v39, v14
v_perm_b32 v51, v39, v39, v15
v_perm_b32 v52, v183, v183, v12
v_perm_b32 v53, v183, v183, v13
v_perm_b32 v54, v183, v183, v14
v_perm_b32 v55, v183, v183, v15
s_waitcnt vmcnt(14)
v_mfma_f32_16x16x32_bf16 v[56:59], v[120:123], v[48:51], v[56:59]
v_mfma_f32_16x16x32_bf16 v[60:63], v[120:123], v[52:55], v[60:63]
v_perm_b32 v48, v39, v39, v16
v_perm_b32 v49, v39, v39, v17
v_perm_b32 v50, v39, v39, v18
v_perm_b32 v51, v39, v39, v19
v_perm_b32 v52, v183, v183, v16
v_perm_b32 v53, v183, v183, v17
v_perm_b32 v54, v183, v183, v18
v_perm_b32 v55, v183, v183, v19
s_waitcnt vmcnt(13)
v_mfma_f32_16x16x32_bf16 v[56:59], v[124:127], v[48:51], v[56:59]
v_mfma_f32_16x16x32_bf16 v[60:63], v[124:127], v[52:55], v[60:63]
v_perm_b32 v48, v40, v40, v12
v_perm_b32 v49, v40, v40, v13
v_perm_b32 v50, v40, v40, v14
v_perm_b32 v51, v40, v40, v15
v_perm_b32 v52, v184, v184, v12
v_perm_b32 v53, v184, v184, v13
v_perm_b32 v54, v184, v184, v14
v_perm_b32 v55, v184, v184, v15
s_waitcnt vmcnt(12)
v_mfma_f32_16x16x32_bf16 v[56:59], v[128:131], v[48:51], v[56:59]
v_mfma_f32_16x16x32_bf16 v[60:63], v[128:131], v[52:55], v[60:63]
v_perm_b32 v48, v40, v40, v16
v_perm_b32 v49, v40, v40, v17
v_perm_b32 v50, v40, v40, v18
v_perm_b32 v51, v40, v40, v19
v_perm_b32 v52, v184, v184, v16
v_perm_b32 v53, v184, v184, v17
v_perm_b32 v54, v184, v184, v18
v_perm_b32 v55, v184, v184, v19
s_waitcnt vmcnt(11)
v_mfma_f32_16x16x32_bf16 v[56:59], v[132:135], v[48:51], v[56:59]
v_mfma_f32_16x16x32_bf16 v[60:63], v[132:135], v[52:55], v[60:63]
v_perm_b32 v48, v41, v41, v12
v_perm_b32 v49, v41, v41, v13
v_perm_b32 v50, v41, v41, v14
v_perm_b32 v51, v41, v41, v15
v_perm_b32 v52, v185, v185, v12
v_perm_b32 v53, v185, v185, v13
v_perm_b32 v54, v185, v185, v14
v_perm_b32 v55, v185, v185, v15
s_waitcnt vmcnt(10)
v_mfma_f32_16x16x32_bf16 v[56:59], v[136:139], v[48:51], v[56:59]
v_mfma_f32_16x16x32_bf16 v[60:63], v[136:139], v[52:55], v[60:63]
v_perm_b32 v48, v41, v41, v16
v_perm_b32 v49, v41, v41, v17
v_perm_b32 v50, v41, v41, v18
v_perm_b32 v51, v41, v41, v19
v_perm_b32 v52, v185, v185, v16
v_perm_b32 v53, v185, v185, v17
v_perm_b32 v54, v185, v185, v18
v_perm_b32 v55, v185, v185, v19
s_waitcnt vmcnt(9)
v_mfma_f32_16x16x32_bf16 v[56:59], v[140:143], v[48:51], v[56:59]
v_mfma_f32_16x16x32_bf16 v[60:63], v[140:143], v[52:55], v[60:63]
v_perm_b32 v48, v42, v42, v12
v_perm_b32 v49, v42, v42, v13
v_perm_b32 v50, v42, v42, v14
v_perm_b32 v51, v42, v42, v15
v_perm_b32 v52, v186, v186, v12
v_perm_b32 v53, v186, v186, v13
v_perm_b32 v54, v186, v186, v14
v_perm_b32 v55, v186, v186, v15
s_waitcnt vmcnt(8)
v_mfma_f32_16x16x32_bf16 v[56:59], v[144:147], v[48:51], v[56:59]
v_mfma_f32_16x16x32_bf16 v[60:63], v[144:147], v[52:55], v[60:63]
v_perm_b32 v48, v42, v42, v16
v_perm_b32 v49, v42, v42, v17
v_perm_b32 v50, v42, v42, v18
v_perm_b32 v51, v42, v42, v19
v_perm_b32 v52, v186, v186, v16
v_perm_b32 v53, v186, v186, v17
v_perm_b32 v54, v186, v186, v18
v_perm_b32 v55, v186, v186, v19
s_waitcnt vmcnt(7)
v_mfma_f32_16x16x32_bf16 v[56:59], v[148:151], v[48:51], v[56:59]
v_mfma_f32_16x16x32_bf16 v[60:63], v[148:151], v[52:55], v[60:63]
v_perm_b32 v48, v43, v43, v12
v_perm_b32 v49, v43, v43, v13
v_perm_b32 v50, v43, v43, v14
v_perm_b32 v51, v43, v43, v15
v_perm_b32 v52, v187, v187, v12
v_perm_b32 v53, v187, v187, v13
v_perm_b32 v54, v187, v187, v14
v_perm_b32 v55, v187, v187, v15
s_waitcnt vmcnt(6)
v_mfma_f32_16x16x32_bf16 v[56:59], v[152:155], v[48:51], v[56:59]
v_mfma_f32_16x16x32_bf16 v[60:63], v[152:155], v[52:55], v[60:63]
v_perm_b32 v48, v43, v43, v16
v_perm_b32 v49, v43, v43, v17
v_perm_b32 v50, v43, v43, v18
v_perm_b32 v51, v43, v43, v19
v_perm_b32 v52, v187, v187, v16
v_perm_b32 v53, v187, v187, v17
v_perm_b32 v54, v187, v187, v18
v_perm_b32 v55, v187, v187, v19
s_waitcnt vmcnt(5)
v_mfma_f32_16x16x32_bf16 v[56:59], v[156:159], v[48:51], v[56:59]
v_mfma_f32_16x16x32_bf16 v[60:63], v[156:159], v[52:55], v[60:63]
v_perm_b32 v48, v44, v44, v12
v_perm_b32 v49, v44, v44, v13
v_perm_b32 v50, v44, v44, v14
v_perm_b32 v51, v44, v44, v15
v_perm_b32 v52, v188, v188, v12
v_perm_b32 v53, v188, v188, v13
v_perm_b32 v54, v188, v188, v14
v_perm_b32 v55, v188, v188, v15
s_waitcnt vmcnt(4)
v_mfma_f32_16x16x32_bf16 v[56:59], v[160:163], v[48:51], v[56:59]
v_mfma_f32_16x16x32_bf16 v[60:63], v[160:163], v[52:55], v[60:63]
v_perm_b32 v48, v44, v44, v16
v_perm_b32 v49, v44, v44, v17
v_perm_b32 v50, v44, v44, v18
v_perm_b32 v51, v44, v44, v19
v_perm_b32 v52, v188, v188, v16
v_perm_b32 v53, v188, v188, v17
v_perm_b32 v54, v188, v188, v18
v_perm_b32 v55, v188, v188, v19
s_waitcnt vmcnt(3)
v_mfma_f32_16x16x32_bf16 v[56:59], v[164:167], v[48:51], v[56:59]
v_mfma_f32_16x16x32_bf16 v[60:63], v[164:167], v[52:55], v[60:63]
v_perm_b32 v48, v45, v45, v12
v_perm_b32 v49, v45, v45, v13
v_perm_b32 v50, v45, v45, v14
v_perm_b32 v51, v45, v45, v15
v_perm_b32 v52, v189, v189, v12
v_perm_b32 v53, v189, v189, v13
v_perm_b32 v54, v189, v189, v14
v_perm_b32 v55, v189, v189, v15
s_waitcnt vmcnt(2)
v_mfma_f32_16x16x32_bf16 v[56:59], v[168:171], v[48:51], v[56:59]
v_mfma_f32_16x16x32_bf16 v[60:63], v[168:171], v[52:55], v[60:63]
v_perm_b32 v48, v45, v45, v16
v_perm_b32 v49, v45, v45, v17
v_perm_b32 v50, v45, v45, v18
v_perm_b32 v51, v45, v45, v19
v_perm_b32 v52, v189, v189, v16
v_perm_b32 v53, v189, v189, v17
v_perm_b32 v54, v189, v189, v18
v_perm_b32 v55, v189, v189, v19
s_waitcnt vmcnt(1)
v_mfma_f32_16x16x32_bf16 v[56:59], v[172:175], v[48:51], v[56:59]
v_mfma_f32_16x16x32_bf16 v[60:63], v[172:175], v[52:55], v[60:63]
v_lshlrev_b32 v23, 4, v1
s_lshl_b32 s46, s50, 11
s_add_u32 s46, s46, 131072
s_lshl_b32 s47, s56, 7
s_add_u32 s47, s47, s46
s_mov_b32 exec_lo, 0
s_nop 2
v_mov_b32 v56, v60
v_mov_b32 v57, v61
v_mov_b32 v58, v62
v_mov_b32 v59, v63
s_mov_b32 exec_lo, 0x00ffff00
s_mov_b32 exec_hi, 0x00ffff00
v_mov_b32 v56, 0
v_mov_b32 v57, 0
v_mov_b32 v58, 0
v_mov_b32 v59, 0
s_mov_b64 exec, -1
v_add_f32_dpp v56, v56, v56 row_ror:8 row_mask:0xf bank_mask:0xf
v_add_f32_dpp v57, v57, v57 row_ror:8 row_mask:0xf bank_mask:0xf
v_add_f32_dpp v58, v58, v58 row_ror:8 row_mask:0xf bank_mask:0xf
v_add_f32_dpp v59, v59, v59 row_ror:8 row_mask:0xf bank_mask:0xf
v_mov_b32 v60, v56
v_mov_b32 v61, v57
v_mov_b32 v62, v58
v_mov_b32 v63, v59
s_nop 0
v_permlane16_swap_b32 v56, v60
v_permlane16_swap_b32 v57, v61
v_permlane16_swap_b32 v58, v62
v_permlane16_swap_b32 v59, v63
v_add_f32 v56, v56, v60
v_add_f32 v57, v57, v61
v_add_f32 v58, v58, v62
v_add_f32 v59, v59, v63
v_mov_b32 v60, v56
v_mov_b32 v61, v57
v_mov_b32 v62, v58
v_mov_b32 v63, v59
s_nop 0
v_permlane32_swap_b32 v56, v60
v_permlane32_swap_b32 v57, v61
v_permlane32_swap_b32 v58, v62
v_permlane32_swap_b32 v59, v63
v_add_f32 v56, v56, v60
v_add_f32 v57, v57, v61
v_add_f32 v58, v58, v62
v_add_f32 v59, v59, v63
v_cvt_pk_bf16_f32 v56, 0, v56
v_cvt_pk_bf16_f32 v57, 0, v57
v_cvt_pk_bf16_f32 v58, 0, v58
v_cvt_pk_bf16_f32 v59, 0, v59
v_or_b32 v56, v56, v212
v_or_b32 v57, v57, v213
v_or_b32 v58, v58, v214
v_or_b32 v59, v59, v215
s_waitcnt vmcnt(0)
s_mov_b64 exec, 0xff
buffer_store_dwordx4 v[56:59], v23, s[36:39], s47 offen sc1
s_mov_b64 exec, -1
v_lshrrev_b32 v22, 3, v1
v_lshlrev_b32 v22, 6, v22
v_lshl_add_u32 v22, v3, 1, v22
v_add_u32 v22, 147712, v22
s_waitcnt vmcnt(0)
L_h_qpoll:
buffer_load_dwordx4 v[64:67], v23, s[36:39], s46 offen sc1
buffer_load_dwordx4 v[68:71], v23, s[36:39], s46 offen offset:1024 sc1
s_waitcnt vmcnt(0)
v_xor_b32 v64, v64, v212
v_xor_b32 v65, v65, v213
v_xor_b32 v66, v66, v214
v_xor_b32 v67, v67, v215
v_xor_b32 v68, v68, v212
v_xor_b32 v69, v69, v213
v_xor_b32 v70, v70, v214
v_xor_b32 v71, v71, v215
v_or_b32 v27, v64, v65
v_or3_b32 v27, v27, v66, v67
v_or3_b32 v27, v27, v68, v69
v_or3_b32 v27, v27, v70, v71
v_and_b32 v27, s59, v27
v_cmp_ne_u32 vcc, 0, v27
s_cbranch_vccz L_h_qgo
s_sleep 4
s_sub_u32 s45, s45, 1
s_cmp_lg_u32 s45, 0
s_cbranch_scc1 L_h_qpoll
s_endpgm
L_h_qgo:
ds_write_b16_d16_hi v22, v64 offset:0
ds_write_b16_d16_hi v22, v65 offset:16
ds_write_b16_d16_hi v22, v66 offset:32
ds_write_b16_d16_hi v22, v67 offset:48
ds_write_b16_d16_hi v22, v68 offset:512
ds_write_b16_d16_hi v22, v69 offset:528
ds_write_b16_d16_hi v22, v70 offset:544
ds_write_b16_d16_hi v22, v71 offset:560
v_mov_b32 v24, 147456
v_mov_b32 v25, 1
s_waitcnt lgkmcnt(0)
ds_write_b32 v24, v25 offset:4
s_mov_b32 s56, s50
s_cmp_lg_u32 s51, s50
s_cbranch_scc1 L_h_noffn
s_cmp_ge_u32 s50, 14
s_cbranch_scc1 L_h_noffn
s_mov_b32 s28, s16
s_and_b32 s29, s17, 0xffff
s_mov_b32 s30, 1605632
s_mov_b32 s31, 0x20000
s_mov_b32 s32, s18
s_and_b32 s33, s19, 0xffff
s_mov_b32 s34, 1605632
s_mov_b32 s35, 0x20000
v_mul_u32_u24 v23, 401408, v11
v_lshl_add_u32 v23, v10, 4, v23
v_cmp_le_u32 vcc, 16, v10
v_bfrev_b32 v27, 2
s_mul_i32 s46, s56, 256
v_cndmask_b32 v23, v23, v27, vcc
v_lshrrev_b32 v22, 3, v10
v_mul_u32_u24 v22, 896, v22
v_mul_u32_u24 v24, 224, v11
v_add3_u32 v22, v22, v24, 0
v_add_u32 v22, 148736, v22
v_mov_b32 v56, 0
v_mov_b32 v57, 0
v_mov_b32 v58, 0
v_mov_b32 v59, 0
v_mov_b32 v60, 0
v_mov_b32 v61, 0
v_mov_b32 v62, 0
v_mov_b32 v63, 0
s_waitcnt vmcnt(0)
buffer_load_dwordx4 v[64:67], v23, s[28:31], s46 offen nt
buffer_load_dwordx4 v[68:71], v23, s[32:35], s46 offen nt
s_add_u32 s46, s46, 3584
buffer_load_dwordx4 v[72:75], v23, s[28:31], s46 offen nt
buffer_load_dwordx4 v[76:79], v23, s[32:35], s46 offen nt
s_add_u32 s46, s46, 3584
buffer_load_dwordx4 v[80:83], v23, s[28:31], s46 offen nt
buffer_load_dwordx4 v[84:87], v23, s[32:35], s46 offen nt
s_add_u32 s46, s46, 3584
buffer_load_dwordx4 v[88:91], v23, s[28:31], s46 offen nt
buffer_load_dwordx4 v[92:95], v23, s[32:35], s46 offen nt
s_add_u32 s46, s46, 3584
buffer_load_dwordx4 v[96:99], v23, s[28:31], s46 offen nt
buffer_load_dwordx4 v[100:103], v23, s[32:35], s46 offen nt
s_add_u32 s46, s46, 3584
buffer_load_dwordx4 v[104:107], v23, s[28:31], s46 offen nt
buffer_load_dwordx4 v[108:111], v23, s[32:35], s46 offen nt
s_add_u32 s46, s46, 3584
buffer_load_dwordx4 v[112:115], v23, s[28:31], s46 offen nt
buffer_load_dwordx4 v[116:119], v23, s[32:35], s46 offen nt
s_add_u32 s46, s46, 3584
buffer_load_dwordx4 v[120:123], v23, s[28:31], s46 offen nt
buffer_load_dwordx4 v[124:127], v23, s[32:35], s46 offen nt
s_add_u32 s46, s46, 3584
s_mov_b32 s57, 13
L_h_f1:
ds_read_b128 v[32:35], v22 offset:0
v_add_u32 v22, 16, v22
s_waitcnt lgkmcnt(0)
v_perm_b32 v48, v32, v32, v12
v_perm_b32 v49, v32, v32, v13
v_perm_b32 v50, v32, v32, v14
v_perm_b32 v51, v32, v32, v15
s_waitcnt vmcnt(14)
s_nop 0
v_mfma_f32_16x16x32_bf16 v[56:59], v[64:67], v[48:51], v[56:59]
v_mfma_f32_16x16x32_bf16 v[60:63], v[68:71], v[48:51], v[60:63]
buffer_load_dwordx4 v[64:67], v23, s[28:31], s46 offen nt
buffer_load_dwordx4 v[68:71], v23, s[32:35], s46 offen nt
s_add_u32 s46, s46, 3584
v_perm_b32 v52, v32, v32, v16
v_perm_b32 v53, v32, v32, v17
v_perm_b32 v54, v32, v32, v18
v_perm_b32 v55, v32, v32, v19
s_waitcnt vmcnt(14)
s_nop 0
v_mfma_f32_16x16x32_bf16 v[56:59], v[72:75], v[52:55], v[56:59]
v_mfma_f32_16x16x32_bf16 v[60:63], v[76:79], v[52:55], v[60:63]
buffer_load_dwordx4 v[72:75], v23, s[28:31], s46 offen nt
buffer_load_dwordx4 v[76:79], v23, s[32:35], s46 offen nt
s_add_u32 s46, s46, 3584
v_perm_b32 v48, v33, v33, v12
v_perm_b32 v49, v33, v33, v13
v_perm_b32 v50, v33, v33, v14
v_perm_b32 v51, v33, v33, v15
s_waitcnt vmcnt(14)
s_nop 0
v_mfma_f32_16x16x32_bf16 v[56:59], v[80:83], v[48:51], v[56:59]
v_mfma_f32_16x16x32_bf16 v[60:63], v[84:87], v[48:51], v[60:63]
buffer_load_dwordx4 v[80:83], v23, s[28:31], s46 offen nt
buffer_load_dwordx4 v[84:87], v23, s[32:35], s46 offen nt
s_add_u32 s46, s46, 3584
v_perm_b32 v52, v33, v33, v16
v_perm_b32 v53, v33, v33, v17
v_perm_b32 v54, v33, v33, v18
v_perm_b32 v55, v33, v33, v19
s_waitcnt vmcnt(14)
s_nop 0
v_mfma_f32_16x16x32_bf16 v[56:59], v[88:91], v[52:55], v[56:59]
v_mfma_f32_16x16x32_bf16 v[60:63], v[92:95], v[52:55], v[60:63]
buffer_load_dwordx4 v[88:91], v23, s[28:31], s46 offen nt
buffer_load_dwordx4 v[92:95], v23, s[32:35], s46 offen nt
s_add_u32 s46, s46, 3584
v_perm_b32 v48, v34, v34, v12
v_perm_b32 v49, v34, v34, v13
v_perm_b32 v50, v34, v34, v14
v_perm_b32 v51, v34, v34, v15
s_waitcnt vmcnt(14)
s_nop 0
v_mfma_f32_16x16x32_bf16 v[56:59], v[96:99], v[48:51], v[56:59]
v_mfma_f32_16x16x32_bf16 v[60:63], v[100:103], v[48:51], v[60:63]
buffer_load_dwordx4 v[96:99], v23, s[28:31], s46 offen nt
buffer_load_dwordx4 v[100:103], v23, s[32:35], s46 offen nt
s_add_u32 s46, s46, 3584
v_perm_b32 v52, v34, v34, v16
v_perm_b32 v53, v34, v34, v17
v_perm_b32 v54, v34, v34, v18
v_perm_b32 v55, v34, v34, v19
s_waitcnt vmcnt(14)
s_nop 0
v_mfma_f32_16x16x32_bf16 v[56:59], v[104:107], v[52:55], v[56:59]
v_mfma_f32_16x16x32_bf16 v[60:63], v[108:111], v[52:55], v[60:63]
buffer_load_dwordx4 v[104:107], v23, s[28:31], s46 offen nt
buffer_load_dwordx4 v[108:111], v23, s[32:35], s46 offen nt
s_add_u32 s46, s46, 3584
v_perm_b32 v48, v35, v35, v12
v_perm_b32 v49, v35, v35, v13
v_perm_b32 v50, v35, v35, v14
v_perm_b32 v51, v35, v35, v15
s_waitcnt vmcnt(14)
s_nop 0
v_mfma_f32_16x16x32_bf16 v[56:59], v[112:115], v[48:51], v[56:59]
v_mfma_f32_16x16x32_bf16 v[60:63], v[116:119], v[48:51], v[60:63]
buffer_load_dwordx4 v[112:115], v23, s[28:31], s46 offen nt
buffer_load_dwordx4 v[116:119], v23, s[32:35], s46 offen nt
s_add_u32 s46, s46, 3584
v_perm_b32 v52, v35, v35, v16
v_perm_b32 v53, v35, v35, v17
v_perm_b32 v54, v35, v35, v18
v_perm_b32 v55, v35, v35, v19
s_waitcnt vmcnt(14)
s_nop 0
v_mfma_f32_16x16x32_bf16 v[56:59], v[120:123], v[52:55], v[56:59]
v_mfma_f32_16x16x32_bf16 v[60:63], v[124:127], v[52:55], v[60:63]
buffer_load_dwordx4 v[120:123], v23, s[28:31], s46 offen nt
buffer_load_dwordx4 v[124:127], v23, s[32:35], s46 offen nt
s_add_u32 s46, s46, 3584
s_sub_u32 s57, s57, 1
s_cmp_lg_u32 s57, 0
s_cbranch_scc1 L_h_f1
ds_read_b128 v[32:35], v22 offset:0
v_add_u32 v22, 16, v22
s_waitcnt lgkmcnt(0)
v_perm_b32 v48, v32, v32, v12
v_perm_b32 v49, v32, v32, v13
v_perm_b32 v50, v32, v32, v14
v_perm_b32 v51, v32, v32, v15
s_waitcnt vmcnt(14)
s_nop 0
v_mfma_f32_16x16x32_bf16 v[56:59], v[64:67], v[48:51], v[56:59]
v_mfma_f32_16x16x32_bf16 v[60:63], v[68:71], v[48:51], v[60:63]
v_perm_b32 v52, v32, v32, v16
v_perm_b32 v53, v32, v32, v17
v_perm_b32 v54, v32, v32, v18
v_perm_b32 v55, v32, v32, v19
s_waitcnt vmcnt(12)
s_nop 0
v_mfma_f32_16x16x32_bf16 v[56:59], v[72:75], v[52:55], v[56:59]
v_mfma_f32_16x16x32_bf16 v[60:63], v[76:79], v[52:55], v[60:63]
v_perm_b32 v48, v33, v33, v12
v_perm_b32 v49, v33, v33, v13
v_perm_b32 v50, v33, v33, v14
v_perm_b32 v51, v33, v33, v15
s_waitcnt vmcnt(10)
s_nop 0
v_mfma_f32_16x16x32_bf16 v[56:59], v[80:83], v[48:51], v[56:59]
v_mfma_f32_16x16x32_bf16 v[60:63], v[84:87], v[48:51], v[60:63]
v_perm_b32 v52, v33, v33, v16
v_perm_b32 v53, v33, v33, v17
v_perm_b32 v54, v33, v33, v18
v_perm_b32 v55, v33, v33, v19
s_waitcnt vmcnt(8)
s_nop 0
v_mfma_f32_16x16x32_bf16 v[56:59], v[88:91], v[52:55], v[56:59]
v_mfma_f32_16x16x32_bf16 v[60:63], v[92:95], v[52:55], v[60:63]
v_perm_b32 v48, v34, v34, v12
v_perm_b32 v49, v34, v34, v13
v_perm_b32 v50, v34, v34, v14
v_perm_b32 v51, v34, v34, v15
s_waitcnt vmcnt(6)
s_nop 0
v_mfma_f32_16x16x32_bf16 v[56:59], v[96:99], v[48:51], v[56:59]
v_mfma_f32_16x16x32_bf16 v[60:63], v[100:103], v[48:51], v[60:63]
v_perm_b32 v52, v34, v34, v16
v_perm_b32 v53, v34, v34, v17
v_perm_b32 v54, v34, v34, v18
v_perm_b32 v55, v34, v34, v19
s_waitcnt vmcnt(4)
s_nop 0
v_mfma_f32_16x16x32_bf16 v[56:59], v[104:107], v[52:55], v[56:59]
v_mfma_f32_16x16x32_bf16 v[60:63], v[108:111], v[52:55], v[60:63]
v_perm_b32 v48, v35, v35, v12
v_perm_b32 v49, v35, v35, v13
v_perm_b32 v50, v35, v35, v14
v_perm_b32 v51, v35, v35, v15
s_waitcnt vmcnt(2)
s_nop 0
v_mfma_f32_16x16x32_bf16 v[56:59], v[112:115], v[48:51], v[56:59]
v_mfma_f32_16x16x32_bf16 v[60:63], v[116:119], v[48:51], v[60:63]
v_perm_b32 v52, v35, v35, v16
v_perm_b32 v53, v35, v35, v17
v_perm_b32 v54, v35, v35, v18
v_perm_b32 v55, v35, v35, v19
s_waitcnt vmcnt(0)
s_nop 0
v_mfma_f32_16x16x32_bf16 v[56:59], v[120:123], v[52:55], v[56:59]
v_mfma_f32_16x16x32_bf16 v[60:63], v[124:127], v[52:55], v[60:63]
s_mov_b32 s28, s20
s_and_b32 s29, s21, 0xffff
s_mov_b32 s30, 1605632
s_mov_b32 s31, 0x20000
v_mul_u32_u24 v23, 28672, v11
v_lshl_add_u32 v23, v10, 4, v23
v_cmp_le_u32 vcc, 8, v10
s_mul_i32 s46, s56, 114688
s_nop 0
v_cndmask_b32 v26, v23, v27, vcc
s_nop 4
v_mov_b32 v30, 147456
L_h_fp2:
ds_read_b32 v29, v30
s_waitcnt lgkmcnt(0)
v_readfirstlane_b32 s75, v29
s_and_b32 s75, s75, 0x7fff
s_cmp_ge_u32 s75, 47
s_cbranch_scc1 L_h_fp2_go
s_sleep 8
s_sub_u32 s45, s45, 1
s_cmp_lg_u32 s45, 0
s_cbranch_scc1 L_h_fp2
s_endpgm
L_h_fp2_go:
buffer_load_dwordx4 v[64:67], v23, s[28:31], s46 offen offset:0 nt
buffer_load_dwordx4 v[68:71], v23, s[28:31], s46 offen offset:256 nt
buffer_load_dwordx4 v[72:75], v23, s[28:31], s46 offen offset:512 nt
buffer_load_dwordx4 v[76:79], v26, s[28:31], s46 offen offset:768 nt
s_add_u32 s46, s46, 896
buffer_load_dwordx4 v[80:83], v23, s[28:31], s46 offen offset:0 nt
buffer_load_dwordx4 v[84:87], v23, s[28:31], s46 offen offset:256 nt
buffer_load_dwordx4 v[88:91], v23, s[28:31], s46 offen offset:512 nt
buffer_load_dwordx4 v[92:95], v26, s[28:31], s46 offen offset:768 nt
s_add_u32 s46, s46, 896
buffer_load_dwordx4 v[96:99], v23, s[28:31], s46 offen offset:0 nt
buffer_load_dwordx4 v[100:103], v23, s[28:31], s46 offen offset:256 nt
buffer_load_dwordx4 v[104:107], v23, s[28:31], s46 offen offset:512 nt
buffer_load_dwordx4 v[108:111], v26, s[28:31], s46 offen offset:768 nt
s_add_u32 s46, s46, 896
buffer_load_dwordx4 v[112:115], v23, s[28:31], s46 offen offset:0 nt
buffer_load_dwordx4 v[116:119], v23, s[28:31], s46 offen offset:256 nt
buffer_load_dwordx4 v[120:123], v23, s[28:31], s46 offen offset:512 nt
buffer_load_dwordx4 v[124:127], v26, s[28:31], s46 offen offset:768 nt
s_add_u32 s46, s46, 896
v_cvt_pk_bf16_f32 v32, v56, v57
v_cvt_pk_bf16_f32 v33, v58, v59
v_cvt_pk_bf16_f32 v34, v60, v61
v_cvt_pk_bf16_f32 v35, v62, v63
v_lshlrev_b32 v36, 16, v32
v_and_b32 v37, 0xffff0000, v32
v_lshlrev_b32 v38, 16, v33
v_and_b32 v39, 0xffff0000, v33
v_lshlrev_b32 v40, 16, v34
v_and_b32 v41, 0xffff0000, v34
v_lshlrev_b32 v42, 16, v35
v_and_b32 v43, 0xffff0000, v35
s_mov_b32 s71, 0x3d372713
v_mul_f32 v44, v36, v36
v_mul_f32 v44, v44, v36
v_fma_f32 v44, v44, s71, v36
v_mul_f32 v44, 0xc0135761, v44
v_mul_f32 v45, v37, v37
v_mul_f32 v45, v45, v37
v_fma_f32 v45, v45, s71, v37
v_mul_f32 v45, 0xc0135761, v45
v_mul_f32 v46, v38, v38
v_mul_f32 v46, v46, v38
v_fma_f32 v46, v46, s71, v38
v_mul_f32 v46, 0xc0135761, v46
v_mul_f32 v47, v39, v39
v_mul_f32 v47, v47, v39
v_fma_f32 v47, v47, s71, v39
v_mul_f32 v47, 0xc0135761, v47
v_exp_f32 v44, v44
v_exp_f32 v45, v45
v_exp_f32 v46, v46
v_exp_f32 v47, v47
s_nop 0
v_add_f32 v44, 1.0, v44
v_add_f32 v45, 1.0, v45
v_add_f32 v46, 1.0, v46
v_add_f32 v47, 1.0, v47
v_rcp_f32 v44, v44
v_rcp_f32 v45, v45
v_rcp_f32 v46, v46
v_rcp_f32 v47, v47
s_nop 0
v_mul_f32 v44, v44, v36
v_mul_f32 v45, v45, v37
v_mul_f32 v46, v46, v38
v_mul_f32 v47, v47, v39
v_cvt_pk_bf16_f32 v32, v44, v45
v_cvt_pk_bf16_f32 v33, v46, v47
v_lshlrev_b32 v44, 16, v32
v_and_b32 v45, 0xffff0000, v32
v_lshlrev_b32 v46, 16, v33
v_and_b32 v47, 0xffff0000, v33
v_mul_f32 v44, v44, v40
v_mul_f32 v45, v45, v41
v_mul_f32 v46, v46, v42
v_mul_f32 v47, v47, v43
v_cvt_pk_bf16_f32 v32, v44, v45
v_cvt_pk_bf16_f32 v33, v46, v47
v_lshrrev_b32 v22, 3, v10
v_lshlrev_b32 v22, 8, v22
v_add_u32 v22, 150528, v22
v_lshl_add_u32 v24, v11, 6, v22
v_lshl_add_u32 v24, v3, 1, v24
v_mul_u32_u24 v25, 64, v11
v_add_u32 v22, v22, v25
ds_write_b16 v24, v32
ds_write_b16_d16_hi v24, v32 offset:16
ds_write_b16 v24, v33 offset:32
ds_write_b16_d16_hi v24, v33 offset:48
v_mov_b32 v196, 0
v_mov_b32 v197, 0
v_mov_b32 v198, 0
v_mov_b32 v199, 0
v_mov_b32 v200, 0
v_mov_b32 v201, 0
v_mov_b32 v202, 0
v_mov_b32 v203, 0
v_mov_b32 v204, 0
v_mov_b32 v205, 0
v_mov_b32 v206, 0
v_mov_b32 v207, 0
v_mov_b32 v208, 0
v_mov_b32 v209, 0
v_mov_b32 v210, 0
v_mov_b32 v211, 0
s_waitcnt lgkmcnt(0)
s_mov_b32 s57, 7
L_h_f2:
ds_read_b64 v[32:33], v22 offset:0
v_add_u32 v22, 8, v22
s_waitcnt lgkmcnt(0)
v_perm_b32 v48, v32, v32, v12
v_perm_b32 v49, v32, v32, v13
v_perm_b32 v50, v32, v32, v14
v_perm_b32 v51, v32, v32, v15
s_waitcnt vmcnt(12)
s_nop 0
v_mfma_f32_16x16x32_bf16 v[196:199], v[64:67], v[48:51], v[196:199]
v_mfma_f32_16x16x32_bf16 v[200:203], v[68:71], v[48:51], v[200:203]
v_mfma_f32_16x16x32_bf16 v[204:207], v[72:75], v[48:51], v[204:207]
v_mfma_f32_16x16x32_bf16 v[208:211], v[76:79], v[48:51], v[208:211]
buffer_load_dwordx4 v[64:67], v23, s[28:31], s46 offen offset:0 nt
buffer_load_dwordx4 v[68:71], v23, s[28:31], s46 offen offset:256 nt
buffer_load_dwordx4 v[72:75], v23, s[28:31], s46 offen offset:512 nt
buffer_load_dwordx4 v[76:79], v26, s[28:31], s46 offen offset:768 nt
s_add_u32 s46, s46, 896
v_perm_b32 v52, v32, v32, v16
v_perm_b32 v53, v32, v32, v17
v_perm_b32 v54, v32, v32, v18
v_perm_b32 v55, v32, v32, v19
s_waitcnt vmcnt(12)
s_nop 0
v_mfma_f32_16x16x32_bf16 v[196:199], v[80:83], v[52:55], v[196:199]
v_mfma_f32_16x16x32_bf16 v[200:203], v[84:87], v[52:55], v[200:203]
v_mfma_f32_16x16x32_bf16 v[204:207], v[88:91], v[52:55], v[204:207]
v_mfma_f32_16x16x32_bf16 v[208:211], v[92:95], v[52:55], v[208:211]
buffer_load_dwordx4 v[80:83], v23, s[28:31], s46 offen offset:0 nt
buffer_load_dwordx4 v[84:87], v23, s[28:31], s46 offen offset:256 nt
buffer_load_dwordx4 v[88:91], v23, s[28:31], s46 offen offset:512 nt
buffer_load_dwordx4 v[92:95], v26, s[28:31], s46 offen offset:768 nt
s_add_u32 s46, s46, 896
v_perm_b32 v48, v33, v33, v12
v_perm_b32 v49, v33, v33, v13
v_perm_b32 v50, v33, v33, v14
v_perm_b32 v51, v33, v33, v15
s_waitcnt vmcnt(12)
s_nop 0
v_mfma_f32_16x16x32_bf16 v[196:199], v[96:99], v[48:51], v[196:199]
v_mfma_f32_16x16x32_bf16 v[200:203], v[100:103], v[48:51], v[200:203]
v_mfma_f32_16x16x32_bf16 v[204:207], v[104:107], v[48:51], v[204:207]
v_mfma_f32_16x16x32_bf16 v[208:211], v[108:111], v[48:51], v[208:211]
buffer_load_dwordx4 v[96:99], v23, s[28:31], s46 offen offset:0 nt
buffer_load_dwordx4 v[100:103], v23, s[28:31], s46 offen offset:256 nt
buffer_load_dwordx4 v[104:107], v23, s[28:31], s46 offen offset:512 nt
buffer_load_dwordx4 v[108:111], v26, s[28:31], s46 offen offset:768 nt
s_add_u32 s46, s46, 896
v_perm_b32 v52, v33, v33, v16
v_perm_b32 v53, v33, v33, v17
v_perm_b32 v54, v33, v33, v18
v_perm_b32 v55, v33, v33, v19
s_waitcnt vmcnt(12)
s_nop 0
v_mfma_f32_16x16x32_bf16 v[196:199], v[112:115], v[52:55], v[196:199]
v_mfma_f32_16x16x32_bf16 v[200:203], v[116:119], v[52:55], v[200:203]
v_mfma_f32_16x16x32_bf16 v[204:207], v[120:123], v[52:55], v[204:207]
v_mfma_f32_16x16x32_bf16 v[208:211], v[124:127], v[52:55], v[208:211]
buffer_load_dwordx4 v[112:115], v23, s[28:31], s46 offen offset:0 nt
buffer_load_dwordx4 v[116:119], v23, s[28:31], s46 offen offset:256 nt
buffer_load_dwordx4 v[120:123], v23, s[28:31], s46 offen offset:512 nt
buffer_load_dwordx4 v[124:127], v26, s[28:31], s46 offen offset:768 nt
s_add_u32 s46, s46, 896
s_sub_u32 s57, s57, 1
s_cmp_lg_u32 s57, 0
s_cbranch_scc1 L_h_f2
ds_read_b64 v[32:33], v22 offset:0
v_add_u32 v22, 8, v22
s_waitcnt lgkmcnt(0)
v_perm_b32 v48, v32, v32, v12
v_perm_b32 v49, v32, v32, v13
v_perm_b32 v50, v32, v32, v14
v_perm_b32 v51, v32, v32, v15
s_waitcnt vmcnt(12)
s_nop 0
v_mfma_f32_16x16x32_bf16 v[196:199], v[64:67], v[48:51], v[196:199]
v_mfma_f32_16x16x32_bf16 v[200:203], v[68:71], v[48:51], v[200:203]
v_mfma_f32_16x16x32_bf16 v[204:207], v[72:75], v[48:51], v[204:207]
v_mfma_f32_16x16x32_bf16 v[208:211], v[76:79], v[48:51], v[208:211]
v_perm_b32 v52, v32, v32, v16
v_perm_b32 v53, v32, v32, v17
v_perm_b32 v54, v32, v32, v18
v_perm_b32 v55, v32, v32, v19
s_waitcnt vmcnt(8)
s_nop 0
v_mfma_f32_16x16x32_bf16 v[196:199], v[80:83], v[52:55], v[196:199]
v_mfma_f32_16x16x32_bf16 v[200:203], v[84:87], v[52:55], v[200:203]
v_mfma_f32_16x16x32_bf16 v[204:207], v[88:91], v[52:55], v[204:207]
v_mfma_f32_16x16x32_bf16 v[208:211], v[92:95], v[52:55], v[208:211]
v_perm_b32 v48, v33, v33, v12
v_perm_b32 v49, v33, v33, v13
v_perm_b32 v50, v33, v33, v14
v_perm_b32 v51, v33, v33, v15
s_waitcnt vmcnt(4)
s_nop 0
v_mfma_f32_16x16x32_bf16 v[196:199], v[96:99], v[48:51], v[196:199]
v_mfma_f32_16x16x32_bf16 v[200:203], v[100:103], v[48:51], v[200:203]
v_mfma_f32_16x16x32_bf16 v[204:207], v[104:107], v[48:51], v[204:207]
v_mfma_f32_16x16x32_bf16 v[208:211], v[108:111], v[48:51], v[208:211]
v_perm_b32 v52, v33, v33, v16
v_perm_b32 v53, v33, v33, v17
v_perm_b32 v54, v33, v33, v18
v_perm_b32 v55, v33, v33, v19
s_waitcnt vmcnt(0)
s_nop 0
v_mfma_f32_16x16x32_bf16 v[196:199], v[112:115], v[52:55], v[196:199]
v_mfma_f32_16x16x32_bf16 v[200:203], v[116:119], v[52:55], v[200:203]
v_mfma_f32_16x16x32_bf16 v[204:207], v[120:123], v[52:55], v[204:207]
v_mfma_f32_16x16x32_bf16 v[208:211], v[124:127], v[52:55], v[208:211]
v_lshrrev_b32 v22, 3, v10
v_lshlrev_b32 v22, 11, v22
v_lshl_add_u32 v22, v11, 7, v22
v_lshl_add_u32 v22, v3, 4, v22
s_lshl_b32 s46, s56, 12
s_add_u32 s46, s46, 1376256
s_nop 4
v_bfi_b32 v196, s59, v212, v196
v_bfi_b32 v197, s59, v213, v197
v_bfi_b32 v198, s59, v214, v198
v_bfi_b32 v199, s59, v215, v199
v_bfi_b32 v200, s59, v212, v200
v_bfi_b32 v201, s59, v213, v201
v_bfi_b32 v202, s59, v214, v202
v_bfi_b32 v203, s59, v215, v203
v_bfi_b32 v204, s59, v212, v204
v_bfi_b32 v205, s59, v213, v205
v_bfi_b32 v206, s59, v214, v206
v_bfi_b32 v207, s59, v215, v207
v_bfi_b32 v208, s59, v212, v208
v_bfi_b32 v209, s59, v213, v209
v_bfi_b32 v210, s59, v214, v210
v_bfi_b32 v211, s59, v215, v211
buffer_store_dwordx4 v[196:199], v22, s[36:39], s46 offen offset:0 sc1
buffer_store_dwordx4 v[200:203], v22, s[36:39], s46 offen offset:512 sc1
buffer_store_dwordx4 v[204:207], v22, s[36:39], s46 offen offset:1024 sc1
s_mov_b32 exec_hi, 0
buffer_store_dwordx4 v[208:211], v22, s[36:39], s46 offen offset:1536 sc1
s_mov_b64 exec, -1
L_h_noffn:
s_and_b32 s56, s2, 127
s_cmp_eq_u32 s2, 255
s_cbranch_scc1 L_h_epoch
s_cmp_ge_u32 s56, 28
s_cbranch_scc1 L_end
v_lshlrev_b32 v22, 12, v10
v_lshl_add_u32 v22, v11, 4, v22
s_lshl_b32 s46, s52, 11
s_lshl_b32 s47, s56, 6
s_add_u32 s46, s46, s47
s_add_u32 s46, s46, 1376256
v_mov_b32 v64, 0
v_mov_b32 v65, 0
v_mov_b32 v66, 0
v_mov_b32 v67, 0
s_mov_b32 exec_lo, 0x3fff3fff
s_mov_b32 exec_hi, 0x3fff3fff
L_h_ypoll:
buffer_load_dwordx4 v[64:67], v22, s[36:39], s46 offen sc1
s_waitcnt vmcnt(0)
v_xor_b32 v64, v64, v212
v_xor_b32 v65, v65, v213
v_xor_b32 v66, v66, v214
v_xor_b32 v67, v67, v215
v_or_b32 v27, v64, v65
v_or3_b32 v27, v27, v66, v67
v_and_b32 v27, s59, v27
v_cmp_ne_u32 vcc, 0, v27
s_cbranch_vccz L_h_ygo
s_sleep 64
s_sub_u32 s45, s45, 1
s_cmp_lg_u32 s45, 0
s_cbranch_scc1 L_h_ypoll
s_endpgm
L_h_ygo:
s_mov_b64 exec, -1
s_lshr_b32 s47, s56, 1
s_lshl_b32 s47, s47, 5
s_and_b32 s48, s56, 1
s_lshl_b32 s48, s48, 2
s_add_u32 s47, s47, s48
s_mul_i32 s48, s52, 448
s_add_u32 s47, s47, s48
s_lshl_b32 s57, s47, 1
s_mov_b32 s28, s4
s_and_b32 s29, s5, 0xffff
s_mov_b32 s30, 1792
s_mov_b32 s31, 0x20000
s_mov_b32 s32, s22
s_and_b32 s33, s23, 0xffff
s_mov_b32 s34, 1792
s_mov_b32 s35, 0x20000
v_lshlrev_b32 v23, 1, v11
buffer_load_ushort v72, v23, s[28:31], s57 offen offset:0
buffer_load_ushort v73, v23, s[28:31], s57 offen offset:16
buffer_load_ushort v74, v23, s[28:31], s57 offen offset:32
buffer_load_ushort v75, v23, s[28:31], s57 offen offset:48
s_waitcnt vmcnt(0)
v_add_f32_dpp v64, v64, v64 row_ror:8 row_mask:0xf bank_mask:0xf
v_add_f32_dpp v65, v65, v65 row_ror:8 row_mask:0xf bank_mask:0xf
v_add_f32_dpp v66, v66, v66 row_ror:8 row_mask:0xf bank_mask:0xf
v_add_f32_dpp v67, v67, v67 row_ror:8 row_mask:0xf bank_mask:0xf
v_add_f32_dpp v64, v64, v64 row_ror:4 row_mask:0xf bank_mask:0xf
v_add_f32_dpp v65, v65, v65 row_ror:4 row_mask:0xf bank_mask:0xf
v_add_f32_dpp v66, v66, v66 row_ror:4 row_mask:0xf bank_mask:0xf
v_add_f32_dpp v67, v67, v67 row_ror:4 row_mask:0xf bank_mask:0xf
v_add_f32_dpp v64, v64, v64 row_ror:2 row_mask:0xf bank_mask:0xf
v_add_f32_dpp v65, v65, v65 row_ror:2 row_mask:0xf bank_mask:0xf
v_add_f32_dpp v66, v66, v66 row_ror:2 row_mask:0xf bank_mask:0xf
v_add_f32_dpp v67, v67, v67 row_ror:2 row_mask:0xf bank_mask:0xf
v_add_f32_dpp v64, v64, v64 row_ror:1 row_mask:0xf bank_mask:0xf
v_add_f32_dpp v65, v65, v65 row_ror:1 row_mask:0xf bank_mask:0xf
v_add_f32_dpp v66, v66, v66 row_ror:1 row_mask:0xf bank_mask:0xf
v_add_f32_dpp v67, v67, v67 row_ror:1 row_mask:0xf bank_mask:0xf
v_cvt_pk_bf16_f32 v68, v64, v65
v_cvt_pk_bf16_f32 v69, v66, v67
v_lshlrev_b32 v64, 16, v68
v_and_b32 v65, 0xffff0000, v68
v_lshlrev_b32 v66, 16, v69
v_and_b32 v67, 0xffff0000, v69
v_mul_f32 v68, 0xbfb8aa3b, v64
v_mul_f32 v69, 0xbfb8aa3b, v65
v_mul_f32 v70, 0xbfb8aa3b, v66
v_mul_f32 v71, 0xbfb8aa3b, v67
v_exp_f32 v68, v68
v_exp_f32 v69, v69
v_exp_f32 v70, v70
v_exp_f32 v71, v71
s_nop 0
v_add_f32 v68, 1.0, v68
v_add_f32 v69, 1.0, v69
v_add_f32 v70, 1.0, v70
v_add_f32 v71, 1.0, v71
v_rcp_f32 v68, v68
v_rcp_f32 v69, v69
v_rcp_f32 v70, v70
v_rcp_f32 v71, v71
s_nop 0
v_mul_f32 v64, v64, v68
v_mul_f32 v65, v65, v69
v_mul_f32 v66, v66, v70
v_mul_f32 v67, v67, v71
v_cvt_pk_bf16_f32 v68, v64, v65
v_cvt_pk_bf16_f32 v69, v66, v67
v_lshlrev_b32 v76, 16, v68
v_and_b32 v77, 0xffff0000, v68
v_lshlrev_b32 v78, 16, v69
v_and_b32 v79, 0xffff0000, v69
v_lshlrev_b32 v72, 16, v72
v_lshlrev_b32 v73, 16, v73
v_lshlrev_b32 v74, 16, v74
v_lshlrev_b32 v75, 16, v75
v_lshlrev_b32 v22, 7, v10
v_lshl_add_u32 v22, v11, 4, v22
s_lshl_b32 s46, s52, 18
s_lshr_b32 s47, s56, 1
s_lshl_b32 s47, s47, 14
s_add_u32 s46, s46, s47
s_and_b32 s47, s56, 1
s_lshl_b32 s47, s47, 6
s_add_u32 s46, s46, s47
s_add_u32 s46, s46, 851968
s_add_u32 s64, s46, 2048
s_add_u32 s65, s46, 4096
s_add_u32 s66, s46, 6144
s_add_u32 s67, s46, 8192
s_add_u32 s68, s46, 10240
s_add_u32 s69, s46, 12288
s_add_u32 s70, s46, 14336
s_waitcnt vmcnt(0) lgkmcnt(0)
s_barrier
s_barrier
s_barrier
s_barrier
L_h_bpoll:
buffer_load_dwordx4 v[96:99], v22, s[36:39], s46 offen sc1
buffer_load_dwordx4 v[100:103], v22, s[36:39], s64 offen sc1
buffer_load_dwordx4 v[104:107], v22, s[36:39], s65 offen sc1
buffer_load_dwordx4 v[108:111], v22, s[36:39], s66 offen sc1
buffer_load_dwordx4 v[112:115], v22, s[36:39], s67 offen sc1
buffer_load_dwordx4 v[116:119], v22, s[36:39], s68 offen sc1
buffer_load_dwordx4 v[120:123], v22, s[36:39], s69 offen sc1
buffer_load_dwordx4 v[124:127], v22, s[36:39], s70 offen sc1
s_waitcnt vmcnt(7)
v_xor_b32 v96, v96, v212
v_xor_b32 v97, v97, v213
v_xor_b32 v98, v98, v214
v_xor_b32 v99, v99, v215
v_or_b32 v24, v96, v97
v_or3_b32 v24, v24, v98, v99
s_waitcnt vmcnt(6)
v_xor_b32 v100, v100, v212
v_xor_b32 v101, v101, v213
v_xor_b32 v102, v102, v214
v_xor_b32 v103, v103, v215
v_or3_b32 v24, v24, v100, v101
v_or3_b32 v24, v24, v102, v103
s_waitcnt vmcnt(5)
v_xor_b32 v104, v104, v212
v_xor_b32 v105, v105, v213
v_xor_b32 v106, v106, v214
v_xor_b32 v107, v107, v215
v_or3_b32 v24, v24, v104, v105
v_or3_b32 v24, v24, v106, v107
s_waitcnt vmcnt(4)
v_xor_b32 v108, v108, v212
v_xor_b32 v109, v109, v213
v_xor_b32 v110, v110, v214
v_xor_b32 v111, v111, v215
v_or3_b32 v24, v24, v108, v109
v_or3_b32 v24, v24, v110, v111
s_waitcnt vmcnt(3)
v_xor_b32 v112, v112, v212
v_xor_b32 v113, v113, v213
v_xor_b32 v114, v114, v214
v_xor_b32 v115, v115, v215
v_or3_b32 v24, v24, v112, v113
v_or3_b32 v24, v24, v114, v115
s_waitcnt vmcnt(2)
v_xor_b32 v116, v116, v212
v_xor_b32 v117, v117, v213
v_xor_b32 v118, v118, v214
v_xor_b32 v119, v119, v215
v_or3_b32 v24, v24, v116, v117
v_or3_b32 v24, v24, v118, v119
s_waitcnt vmcnt(1)
v_xor_b32 v120, v120, v212
v_xor_b32 v121, v121, v213
v_xor_b32 v122, v122, v214
v_xor_b32 v123, v123, v215
v_or3_b32 v24, v24, v120, v121
v_or3_b32 v24, v24, v122, v123
s_waitcnt vmcnt(0)
v_xor_b32 v124, v124, v212
v_xor_b32 v125, v125, v213
v_xor_b32 v126, v126, v214
v_xor_b32 v127, v127, v215
v_or3_b32 v24, v24, v124, v125
v_or3_b32 v24, v24, v126, v127
v_and_b32 v24, s59, v24
v_cmp_ne_u32 vcc, 0, v24
s_cbranch_vccz L_h_bgo
s_or_b32 s76, vcc_lo, vcc_hi
s_lshr_b32 s77, s76, 16
s_or_b32 s76, s76, s77
s_pack_ll_b32_b16 s76, s76, s76
s_mov_b32 exec_lo, s76
s_mov_b32 exec_hi, s76
s_sleep 1
s_sub_u32 s45, s45, 1
s_cmp_lg_u32 s45, 0
s_cbranch_scc1 L_h_bpoll
s_endpgm
L_h_bgo:
s_mov_b64 exec, -1
v_add_f32 v128, v96, v112
v_add_f32 v129, v97, v113
v_add_f32 v130, v98, v114
v_add_f32 v131, v99, v115
v_add_f32 v132, v100, v116
v_add_f32 v133, v101, v117
v_add_f32 v134, v102, v118
v_add_f32 v135, v103, v119
v_add_f32 v136, v104, v120
v_add_f32 v137, v105, v121
v_add_f32 v138, v106, v122
v_add_f32 v139, v107, v123
v_add_f32 v140, v108, v124
v_add_f32 v141, v109, v125
v_add_f32 v142, v110, v126
v_add_f32 v143, v111, v127
v_add_f32 v128, v128, v136
v_add_f32 v129, v129, v137
v_add_f32 v130, v130, v138
v_add_f32 v131, v131, v139
v_add_f32 v132, v132, v140
v_add_f32 v133, v133, v141
v_add_f32 v134, v134, v142
v_add_f32 v135, v135, v143
v_add_f32 v128, v128, v132
v_add_f32 v129, v129, v133
v_add_f32 v130, v130, v134
v_add_f32 v131, v131, v135
s_nop 0
v_add_f32_dpp v128, v128, v128 row_ror:8 row_mask:0xf bank_mask:0xf
v_add_f32_dpp v129, v129, v129 row_ror:8 row_mask:0xf bank_mask:0xf
v_add_f32_dpp v130, v130, v130 row_ror:8 row_mask:0xf bank_mask:0xf
v_add_f32_dpp v131, v131, v131 row_ror:8 row_mask:0xf bank_mask:0xf
v_add_f32_dpp v128, v128, v128 row_ror:4 row_mask:0xf bank_mask:0xf
v_add_f32_dpp v129, v129, v129 row_ror:4 row_mask:0xf bank_mask:0xf
v_add_f32_dpp v130, v130, v130 row_ror:4 row_mask:0xf bank_mask:0xf
v_add_f32_dpp v131, v131, v131 row_ror:4 row_mask:0xf bank_mask:0xf
v_add_f32_dpp v128, v128, v128 row_ror:2 row_mask:0xf bank_mask:0xf
v_add_f32_dpp v129, v129, v129 row_ror:2 row_mask:0xf bank_mask:0xf
v_add_f32_dpp v130, v130, v130 row_ror:2 row_mask:0xf bank_mask:0xf
v_add_f32_dpp v131, v131, v131 row_ror:2 row_mask:0xf bank_mask:0xf
v_add_f32_dpp v128, v128, v128 row_ror:1 row_mask:0xf bank_mask:0xf
v_add_f32_dpp v129, v129, v129 row_ror:1 row_mask:0xf bank_mask:0xf
v_add_f32_dpp v130, v130, v130 row_ror:1 row_mask:0xf bank_mask:0xf
v_add_f32_dpp v131, v131, v131 row_ror:1 row_mask:0xf bank_mask:0xf
v_cvt_pk_bf16_f32 v132, v128, v129
v_cvt_pk_bf16_f32 v133, v130, v131
v_lshlrev_b32 v128, 16, v132
v_and_b32 v129, 0xffff0000, v132
v_lshlrev_b32 v130, 16, v133
v_and_b32 v131, 0xffff0000, v133
v_mul_f32 v128, v128, v76
v_mul_f32 v129, v129, v77
v_mul_f32 v130, v130, v78
v_mul_f32 v131, v131, v79
v_cvt_pk_bf16_f32 v132, v128, v129
v_cvt_pk_bf16_f32 v133, v130, v131
v_lshlrev_b32 v128, 16, v132
v_and_b32 v129, 0xffff0000, v132
v_lshlrev_b32 v130, 16, v133
v_and_b32 v131, 0xffff0000, v133
v_add_f32 v128, v128, v72
v_add_f32 v129, v129, v73
v_add_f32 v130, v130, v74
v_add_f32 v131, v131, v75
v_cvt_pk_bf16_f32 v132, v128, v129
v_cvt_pk_bf16_f32 v133, v130, v131
s_mov_b32 exec_lo, 0x00010001
s_mov_b32 exec_hi, 0x00010001
buffer_store_short v132, v23, s[32:35], s57 offen
buffer_store_short_d16_hi v132, v23, s[32:35], s57 offen offset:16
buffer_store_short v133, v23, s[32:35], s57 offen offset:32
buffer_store_short_d16_hi v133, v23, s[32:35], s57 offen offset:48
s_mov_b64 exec, -1
L_end:
s_endpgm
L_h_epoch:
v_lshlrev_b32 v22, 12, v11
v_lshl_add_u32 v22, v10, 7, v22
s_mov_b32 s64, 786432
s_mov_b32 s65, 802816
s_mov_b32 s66, 819200
s_mov_b32 s67, 835584
s_waitcnt vmcnt(0) lgkmcnt(0)
s_barrier
s_barrier
s_barrier
s_barrier
L_h_epoll:
buffer_load_dwordx2 v[96:97], v22, s[36:39], s64 offen offset:8 sc1
buffer_load_dwordx2 v[98:99], v22, s[36:39], s65 offen offset:8 sc1
buffer_load_dwordx2 v[100:101], v22, s[36:39], s66 offen offset:8 sc1
buffer_load_dwordx2 v[102:103], v22, s[36:39], s67 offen offset:8 sc1
s_waitcnt vmcnt(0)
v_mov_b32 v24, 0
v_and_b32 v24, s59, v24
v_bitop3_b32 v24, v24, v96, s58 bitop3:0xf6
v_bitop3_b32 v24, v24, v97, s58 bitop3:0xf6
v_bitop3_b32 v24, v24, v98, s58 bitop3:0xf6
v_bitop3_b32 v24, v24, v99, s58 bitop3:0xf6
v_bitop3_b32 v24, v24, v100, s58 bitop3:0xf6
v_bitop3_b32 v24, v24, v101, s58 bitop3:0xf6
v_bitop3_b32 v24, v24, v102, s58 bitop3:0xf6
v_bitop3_b32 v24, v24, v103, s58 bitop3:0xf6
v_cmp_ne_u32 vcc, 0, v24
s_cbranch_vccz L_h_ego
s_sleep 8
s_sub_u32 s45, s45, 1
s_cmp_lg_u32 s45, 0
s_cbranch_scc1 L_h_epoll
s_endpgm
L_h_ego:
v_mov_b32 v24, s58
v_mov_b32 v25, 0
s_mov_b64 exec, 1
buffer_store_dword v24, v25, s[36:39], 0 offen offset:0
s_endpgm
.section .rodata,"a"
.p2align 6
.amdhsa_kernel recurrent_scan__gqa_block_cached__glu_gated_geglu__decode_kernel
  .amdhsa_next_free_vgpr 216
  .amdhsa_next_free_sgpr 102
  .amdhsa_accum_offset 216
  .amdhsa_group_segment_fixed_size 0
  .amdhsa_kernarg_size 96
  .amdhsa_user_sgpr_count 2
  .amdhsa_user_sgpr_kernarg_segment_ptr 1
  .amdhsa_system_sgpr_workgroup_id_x 1
.end_amdhsa_kernel
```
